```python
import torch

def _softmax(x, axis=-1):
    return torch.softmax(x, dim=axis)
def _gelu(x):
    return torch.nn.functional.gelu(x, approximate="tanh")
def _silu(x):
    return torch.nn.functional.silu(x)
def _sigmoid(x):
    return torch.sigmoid(x)
def _layernorm(x, axis=-1, eps=1e-5):
    m = x.mean(dim=axis, keepdim=True)
    v = x.var(dim=axis, keepdim=True, unbiased=False)
    return (x - m) / torch.sqrt(v + eps)
def _scatter_add(tgt, idx, src, axis=0):
    return tgt.clone().index_add_(axis, idx, src)
def _segment_sum(src, seg, n):
    out = torch.zeros((n,) + src.shape[1:], dtype=src.dtype)
    return out.index_add_(0, seg, src)
def _pad(x, pw):
    flat = tuple(v for pair in reversed(pw) for v in pair)
    return torch.nn.functional.pad(x, flat)

kernel_name = 'parallel_sum__gqa_block_cached__geglu_ffn__decode'

def setup_inputs():

    _w = (lambda a: (lambda t: t.to(torch.bfloat16) if t.is_floating_point() else t)(torch.as_tensor(a)))
    def _A_setup():
        B, Sq, D = 2, 1, 448
        Hq, Hkv, Sk, Dh = 16, 8, 32768, 256
        assert Hq % Hkv == 0, (Hq, Hkv)
        return {
            "x": _w((lambda *s: torch.randn(*s, dtype=torch.bfloat16) * 0.05)(B, Sq, D)),
            "k_cache": _w((lambda *s: torch.randn(*s, dtype=torch.bfloat16) * 3.2)(B, Hkv, Sk, Dh)),
            "v_cache": _w((lambda *s: torch.randn(*s, dtype=torch.bfloat16) * 1.6)(B, Hkv, Sk, Dh)),
            "wq": _w((lambda *s: torch.randn(*s, dtype=torch.bfloat16) * 3.2)(D, Hq * Dh) * (D ** -0.5)),
            "wo": _w((lambda *s: torch.randn(*s, dtype=torch.bfloat16) * 1.6)(Hq * Dh, D) * ((Hq * Dh) ** -0.5)),
        }
    _A_in = _A_setup()

    def _B_setup():
        B, S, D, F = 2, 1, 448, 1792
        return {
            "x": _w((lambda *s: torch.randn(*s, dtype=torch.bfloat16) * 0.05)(B, S, D)),
            "w_gate": _w((lambda *s: torch.randn(*s, dtype=torch.bfloat16) * 0.05)(D, F)),
            "w_up": _w((lambda *s: torch.randn(*s, dtype=torch.bfloat16) * 0.05)(D, F)),
            "w_down": _w((lambda *s: torch.randn(*s, dtype=torch.bfloat16) * 0.05)(F, D)),
        }
    _B_in = _B_setup()

    return {
        "A_x": _A_in["x"],
        "A_k_cache": _A_in["k_cache"],
        "A_v_cache": _A_in["v_cache"],
        "A_wq": _A_in["wq"],
        "A_wo": _A_in["wo"],
        "B_x": _B_in["x"],
        "B_w_gate": _B_in["w_gate"],
        "B_w_up": _B_in["w_up"],
        "B_w_down": _B_in["w_down"],
    }

def reference(A_x, A_k_cache, A_v_cache, A_wq, A_wo, B_x, B_w_gate, B_w_up, B_w_down):
    def _A_ref(x, k_cache, v_cache, wq, wo):
        B, Sq, D = x.shape
        Hq, Dh = 16, 256
        Hkv = k_cache.shape[1]
        rep = Hq // Hkv
        q = (lambda x, *d: x.permute(*d))((x @ wq).reshape(B, Sq, Hq, Dh), 0, 2, 1, 3)
        k = (lambda x, n, axis: torch.repeat_interleave(x, n, dim=axis))(k_cache, rep, axis=1)
        v = (lambda x, n, axis: torch.repeat_interleave(x, n, dim=axis))(v_cache, rep, axis=1)
        scores = torch.einsum("bhqd,bhkd->bhqk", q, k) * (Dh ** -0.5)
        p = _softmax(scores, axis=-1)
        o = torch.einsum("bhqk,bhkd->bhqd", p, v)
        return (lambda x, *d: x.permute(*d))(o, 0, 2, 1, 3).reshape(B, Sq, Hq * Dh) @ wo

    def _B_ref(x, w_gate, w_up, w_down):
        return (_gelu(x @ w_gate) * (x @ w_up)) @ w_down

    x = A_x
    xn = _layernorm(x, axis=-1)
    return x + _A_ref(xn, A_k_cache, A_v_cache, A_wq, A_wo) + _B_ref(xn, B_w_gate, B_w_up, B_w_down)
```

```asm
; @launch kernel=prep_kernel grid=(92,1,1) block=(256,1,1) lds=36864
; @launch kernel=attn_kernel grid=(1024,1,1) block=(256,1,1) lds=20736
; @launch kernel=proj_kernel grid=(92,1,1) block=(256,1,1) lds=15360
; @launch kernel=parallel_sum__gqa_block_cached__geglu_ffn__decode_kernel grid=(4,1,1) block=(256,1,1) lds=0
.amdgcn_target "amdgcn-amd-amdhsa--gfx950"
.text
.globl prep_kernel
.p2align 8
.type prep_kernel,@function
prep_kernel:
    s_cmp_ge_u32 s2, 92
    s_cbranch_scc1 K1_END
    s_load_dwordx2 s[4:5], s[0:1], 0
    s_load_dwordx2 s[6:7], s[0:1], 24
    s_load_dwordx2 s[8:9], s[0:1], 48
    s_load_dwordx2 s[10:11], s[0:1], 56
    s_load_dwordx2 s[28:29], s[0:1], 88
    v_and_b32 v1, 63, v0
    v_lshrrev_b32 v2, 6, v0
    s_waitcnt lgkmcnt(0)
    s_mov_b32 s12, s4
    s_and_b32 s13, s5, 0xffff
    s_mov_b32 s14, 0x700
    s_mov_b32 s15, 0x00020000
    s_mov_b32 s16, s6
    s_and_b32 s17, s7, 0xffff
    s_mov_b32 s18, 0x380000
    s_mov_b32 s19, 0x00020000
    s_mov_b32 s20, s8
    s_and_b32 s21, s9, 0xffff
    s_mov_b32 s22, 0x188000
    s_mov_b32 s23, 0x00020000
    s_mov_b32 s24, s10
    s_and_b32 s25, s11, 0xffff
    s_mov_b32 s26, 0x188000
    s_mov_b32 s27, 0x00020000
    s_mov_b32 s32, s28
    s_and_b32 s33, s29, 0xffff
    s_mov_b32 s34, 0x40000000
    s_mov_b32 s35, 0x00020000
    v_mul_u32_u24 v3, 14, v1
    buffer_load_ushort v8, v3, s[12:15], 0 offen offset:0
    buffer_load_ushort v9, v3, s[12:15], 0 offen offset:2
    buffer_load_ushort v10, v3, s[12:15], 0 offen offset:4
    buffer_load_ushort v11, v3, s[12:15], 0 offen offset:6
    buffer_load_ushort v12, v3, s[12:15], 0 offen offset:8
    buffer_load_ushort v13, v3, s[12:15], 0 offen offset:10
    buffer_load_ushort v14, v3, s[12:15], 0 offen offset:12
    buffer_load_ushort v15, v3, s[12:15], 0 offen offset:896
    buffer_load_ushort v16, v3, s[12:15], 0 offen offset:898
    buffer_load_ushort v17, v3, s[12:15], 0 offen offset:900
    buffer_load_ushort v18, v3, s[12:15], 0 offen offset:902
    buffer_load_ushort v19, v3, s[12:15], 0 offen offset:904
    buffer_load_ushort v20, v3, s[12:15], 0 offen offset:906
    buffer_load_ushort v21, v3, s[12:15], 0 offen offset:908
    s_waitcnt vmcnt(0)
    v_lshlrev_b32 v8, 16, v8
    v_lshlrev_b32 v9, 16, v9
    v_lshlrev_b32 v10, 16, v10
    v_lshlrev_b32 v11, 16, v11
    v_lshlrev_b32 v12, 16, v12
    v_lshlrev_b32 v13, 16, v13
    v_lshlrev_b32 v14, 16, v14
    v_lshlrev_b32 v15, 16, v15
    v_lshlrev_b32 v16, 16, v16
    v_lshlrev_b32 v17, 16, v17
    v_lshlrev_b32 v18, 16, v18
    v_lshlrev_b32 v19, 16, v19
    v_lshlrev_b32 v20, 16, v20
    v_lshlrev_b32 v21, 16, v21
    v_mov_b32 v4, v8
    v_add_f32 v4, v4, v9
    v_add_f32 v4, v4, v10
    v_add_f32 v4, v4, v11
    v_add_f32 v4, v4, v12
    v_add_f32 v4, v4, v13
    v_add_f32 v4, v4, v14
    s_nop 1
    v_add_f32_dpp v4, v4, v4 row_shr:1 row_mask:0xf bank_mask:0xf bound_ctrl:0
    s_nop 1
    v_add_f32_dpp v4, v4, v4 row_shr:2 row_mask:0xf bank_mask:0xf bound_ctrl:0
    s_nop 1
    v_add_f32_dpp v4, v4, v4 row_shr:4 row_mask:0xf bank_mask:0xf bound_ctrl:0
    s_nop 1
    v_add_f32_dpp v4, v4, v4 row_shr:8 row_mask:0xf bank_mask:0xf bound_ctrl:0
    s_nop 1
    v_add_f32_dpp v4, v4, v4 row_bcast:15 row_mask:0xa bank_mask:0xf
    s_nop 1
    v_add_f32_dpp v4, v4, v4 row_bcast:31 row_mask:0xc bank_mask:0xf
    s_nop 1
    v_readlane_b32 s40, v4, 63
    s_nop 1
    v_mov_b32 v5, s40
    v_mul_f32 v5, 0x3b124925, v5
    v_sub_f32 v6, v8, v5
    v_mul_f32 v4, v6, v6
    v_sub_f32 v6, v9, v5
    v_fmac_f32 v4, v6, v6
    v_sub_f32 v6, v10, v5
    v_fmac_f32 v4, v6, v6
    v_sub_f32 v6, v11, v5
    v_fmac_f32 v4, v6, v6
    v_sub_f32 v6, v12, v5
    v_fmac_f32 v4, v6, v6
    v_sub_f32 v6, v13, v5
    v_fmac_f32 v4, v6, v6
    v_sub_f32 v6, v14, v5
    v_fmac_f32 v4, v6, v6
    s_nop 1
    v_add_f32_dpp v4, v4, v4 row_shr:1 row_mask:0xf bank_mask:0xf bound_ctrl:0
    s_nop 1
    v_add_f32_dpp v4, v4, v4 row_shr:2 row_mask:0xf bank_mask:0xf bound_ctrl:0
    s_nop 1
    v_add_f32_dpp v4, v4, v4 row_shr:4 row_mask:0xf bank_mask:0xf bound_ctrl:0
    s_nop 1
    v_add_f32_dpp v4, v4, v4 row_shr:8 row_mask:0xf bank_mask:0xf bound_ctrl:0
    s_nop 1
    v_add_f32_dpp v4, v4, v4 row_bcast:15 row_mask:0xa bank_mask:0xf
    s_nop 1
    v_add_f32_dpp v4, v4, v4 row_bcast:31 row_mask:0xc bank_mask:0xf
    s_nop 1
    v_readlane_b32 s40, v4, 63
    s_nop 1
    v_mov_b32 v6, s40
    v_mul_f32 v6, 0x3b124925, v6
    v_cvt_pk_bf16_f32 v5, v5, v5
    v_lshlrev_b32 v5, 16, v5
    v_cvt_pk_bf16_f32 v6, v6, v6
    v_lshlrev_b32 v6, 16, v6
    v_add_f32 v6, 0x3727c5ac, v6
    v_cvt_pk_bf16_f32 v6, v6, v6
    v_lshlrev_b32 v6, 16, v6
    v_sqrt_f32 v6, v6
    s_nop 0
    v_cvt_pk_bf16_f32 v6, v6, v6
    v_lshlrev_b32 v6, 16, v6
    v_rcp_f32 v6, v6
    s_nop 0
    v_sub_f32 v8, v8, v5
    v_cvt_pk_bf16_f32 v8, v8, v8
    v_lshlrev_b32 v8, 16, v8
    v_mul_f32 v8, v8, v6
    v_cvt_pk_bf16_f32 v8, v8, v8
    v_lshlrev_b32 v8, 16, v8
    v_sub_f32 v9, v9, v5
    v_cvt_pk_bf16_f32 v9, v9, v9
    v_lshlrev_b32 v9, 16, v9
    v_mul_f32 v9, v9, v6
    v_cvt_pk_bf16_f32 v9, v9, v9
    v_lshlrev_b32 v9, 16, v9
    v_sub_f32 v10, v10, v5
    v_cvt_pk_bf16_f32 v10, v10, v10
    v_lshlrev_b32 v10, 16, v10
    v_mul_f32 v10, v10, v6
    v_cvt_pk_bf16_f32 v10, v10, v10
    v_lshlrev_b32 v10, 16, v10
    v_sub_f32 v11, v11, v5
    v_cvt_pk_bf16_f32 v11, v11, v11
    v_lshlrev_b32 v11, 16, v11
    v_mul_f32 v11, v11, v6
    v_cvt_pk_bf16_f32 v11, v11, v11
    v_lshlrev_b32 v11, 16, v11
    v_sub_f32 v12, v12, v5
    v_cvt_pk_bf16_f32 v12, v12, v12
    v_lshlrev_b32 v12, 16, v12
    v_mul_f32 v12, v12, v6
    v_cvt_pk_bf16_f32 v12, v12, v12
    v_lshlrev_b32 v12, 16, v12
    v_sub_f32 v13, v13, v5
    v_cvt_pk_bf16_f32 v13, v13, v13
    v_lshlrev_b32 v13, 16, v13
    v_mul_f32 v13, v13, v6
    v_cvt_pk_bf16_f32 v13, v13, v13
    v_lshlrev_b32 v13, 16, v13
    v_sub_f32 v14, v14, v5
    v_cvt_pk_bf16_f32 v14, v14, v14
    v_lshlrev_b32 v14, 16, v14
    v_mul_f32 v14, v14, v6
    v_cvt_pk_bf16_f32 v14, v14, v14
    v_lshlrev_b32 v14, 16, v14
    v_mov_b32 v4, v15
    v_add_f32 v4, v4, v16
    v_add_f32 v4, v4, v17
    v_add_f32 v4, v4, v18
    v_add_f32 v4, v4, v19
    v_add_f32 v4, v4, v20
    v_add_f32 v4, v4, v21
    s_nop 1
    v_add_f32_dpp v4, v4, v4 row_shr:1 row_mask:0xf bank_mask:0xf bound_ctrl:0
    s_nop 1
    v_add_f32_dpp v4, v4, v4 row_shr:2 row_mask:0xf bank_mask:0xf bound_ctrl:0
    s_nop 1
    v_add_f32_dpp v4, v4, v4 row_shr:4 row_mask:0xf bank_mask:0xf bound_ctrl:0
    s_nop 1
    v_add_f32_dpp v4, v4, v4 row_shr:8 row_mask:0xf bank_mask:0xf bound_ctrl:0
    s_nop 1
    v_add_f32_dpp v4, v4, v4 row_bcast:15 row_mask:0xa bank_mask:0xf
    s_nop 1
    v_add_f32_dpp v4, v4, v4 row_bcast:31 row_mask:0xc bank_mask:0xf
    s_nop 1
    v_readlane_b32 s40, v4, 63
    s_nop 1
    v_mov_b32 v5, s40
    v_mul_f32 v5, 0x3b124925, v5
    v_sub_f32 v6, v15, v5
    v_mul_f32 v4, v6, v6
    v_sub_f32 v6, v16, v5
    v_fmac_f32 v4, v6, v6
    v_sub_f32 v6, v17, v5
    v_fmac_f32 v4, v6, v6
    v_sub_f32 v6, v18, v5
    v_fmac_f32 v4, v6, v6
    v_sub_f32 v6, v19, v5
    v_fmac_f32 v4, v6, v6
    v_sub_f32 v6, v20, v5
    v_fmac_f32 v4, v6, v6
    v_sub_f32 v6, v21, v5
    v_fmac_f32 v4, v6, v6
    s_nop 1
    v_add_f32_dpp v4, v4, v4 row_shr:1 row_mask:0xf bank_mask:0xf bound_ctrl:0
    s_nop 1
    v_add_f32_dpp v4, v4, v4 row_shr:2 row_mask:0xf bank_mask:0xf bound_ctrl:0
    s_nop 1
    v_add_f32_dpp v4, v4, v4 row_shr:4 row_mask:0xf bank_mask:0xf bound_ctrl:0
    s_nop 1
    v_add_f32_dpp v4, v4, v4 row_shr:8 row_mask:0xf bank_mask:0xf bound_ctrl:0
    s_nop 1
    v_add_f32_dpp v4, v4, v4 row_bcast:15 row_mask:0xa bank_mask:0xf
    s_nop 1
    v_add_f32_dpp v4, v4, v4 row_bcast:31 row_mask:0xc bank_mask:0xf
    s_nop 1
    v_readlane_b32 s40, v4, 63
    s_nop 1
    v_mov_b32 v6, s40
    v_mul_f32 v6, 0x3b124925, v6
    v_cvt_pk_bf16_f32 v5, v5, v5
    v_lshlrev_b32 v5, 16, v5
    v_cvt_pk_bf16_f32 v6, v6, v6
    v_lshlrev_b32 v6, 16, v6
    v_add_f32 v6, 0x3727c5ac, v6
    v_cvt_pk_bf16_f32 v6, v6, v6
    v_lshlrev_b32 v6, 16, v6
    v_sqrt_f32 v6, v6
    s_nop 0
    v_cvt_pk_bf16_f32 v6, v6, v6
    v_lshlrev_b32 v6, 16, v6
    v_rcp_f32 v6, v6
    s_nop 0
    v_sub_f32 v15, v15, v5
    v_cvt_pk_bf16_f32 v15, v15, v15
    v_lshlrev_b32 v15, 16, v15
    v_mul_f32 v15, v15, v6
    v_cvt_pk_bf16_f32 v15, v15, v15
    v_lshlrev_b32 v15, 16, v15
    v_sub_f32 v16, v16, v5
    v_cvt_pk_bf16_f32 v16, v16, v16
    v_lshlrev_b32 v16, 16, v16
    v_mul_f32 v16, v16, v6
    v_cvt_pk_bf16_f32 v16, v16, v16
    v_lshlrev_b32 v16, 16, v16
    v_sub_f32 v17, v17, v5
    v_cvt_pk_bf16_f32 v17, v17, v17
    v_lshlrev_b32 v17, 16, v17
    v_mul_f32 v17, v17, v6
    v_cvt_pk_bf16_f32 v17, v17, v17
    v_lshlrev_b32 v17, 16, v17
    v_sub_f32 v18, v18, v5
    v_cvt_pk_bf16_f32 v18, v18, v18
    v_lshlrev_b32 v18, 16, v18
    v_mul_f32 v18, v18, v6
    v_cvt_pk_bf16_f32 v18, v18, v18
    v_lshlrev_b32 v18, 16, v18
    v_sub_f32 v19, v19, v5
    v_cvt_pk_bf16_f32 v19, v19, v19
    v_lshlrev_b32 v19, 16, v19
    v_mul_f32 v19, v19, v6
    v_cvt_pk_bf16_f32 v19, v19, v19
    v_lshlrev_b32 v19, 16, v19
    v_sub_f32 v20, v20, v5
    v_cvt_pk_bf16_f32 v20, v20, v20
    v_lshlrev_b32 v20, 16, v20
    v_mul_f32 v20, v20, v6
    v_cvt_pk_bf16_f32 v20, v20, v20
    v_lshlrev_b32 v20, 16, v20
    v_sub_f32 v21, v21, v5
    v_cvt_pk_bf16_f32 v21, v21, v21
    v_lshlrev_b32 v21, 16, v21
    v_mul_f32 v21, v21, v6
    v_cvt_pk_bf16_f32 v21, v21, v21
    v_lshlrev_b32 v21, 16, v21
    v_mul_u32_u24 v3, 28, v1
    ds_write_b32 v3, v8 offset:0
    ds_write_b32 v3, v9 offset:4
    ds_write_b32 v3, v10 offset:8
    ds_write_b32 v3, v11 offset:12
    ds_write_b32 v3, v12 offset:16
    ds_write_b32 v3, v13 offset:20
    ds_write_b32 v3, v14 offset:24
    ds_write_b32 v3, v15 offset:1792
    ds_write_b32 v3, v16 offset:1796
    ds_write_b32 v3, v17 offset:1800
    ds_write_b32 v3, v18 offset:1804
    ds_write_b32 v3, v19 offset:1808
    ds_write_b32 v3, v20 offset:1812
    ds_write_b32 v3, v21 offset:1816
    s_waitcnt lgkmcnt(0)
    v_lshrrev_b32 v4, 3, v1
    v_mul_u32_u24 v5, 112, v2
    v_add_u32 v5, v5, v4
    v_and_b32 v6, 7, v1
    v_lshlrev_b32 v6, 4, v6
    v_lshlrev_b32 v7, 2, v5
    s_cmp_ge_u32 s2, 64
    s_cbranch_scc1 K1_FFN
    s_lshl_b32 s41, s2, 7
    v_lshlrev_b32 v30, 13, v5
    v_add_u32 v30, v30, v6
    s_add_u32 s42, s41, 0
    buffer_load_dwordx4 v[32:35], v30, s[16:19], s42 offen
    s_add_u32 s42, s41, 65536
    buffer_load_dwordx4 v[36:39], v30, s[16:19], s42 offen
    s_add_u32 s42, s41, 131072
    buffer_load_dwordx4 v[40:43], v30, s[16:19], s42 offen
    s_add_u32 s42, s41, 196608
    buffer_load_dwordx4 v[44:47], v30, s[16:19], s42 offen
    s_add_u32 s42, s41, 262144
    buffer_load_dwordx4 v[48:51], v30, s[16:19], s42 offen
    s_add_u32 s42, s41, 327680
    buffer_load_dwordx4 v[52:55], v30, s[16:19], s42 offen
    s_add_u32 s42, s41, 393216
    buffer_load_dwordx4 v[56:59], v30, s[16:19], s42 offen
    s_add_u32 s42, s41, 458752
    buffer_load_dwordx4 v[60:63], v30, s[16:19], s42 offen
    s_add_u32 s42, s41, 524288
    buffer_load_dwordx4 v[64:67], v30, s[16:19], s42 offen
    s_add_u32 s42, s41, 589824
    buffer_load_dwordx4 v[68:71], v30, s[16:19], s42 offen
    s_add_u32 s42, s41, 655360
    buffer_load_dwordx4 v[72:75], v30, s[16:19], s42 offen
    s_add_u32 s42, s41, 720896
    buffer_load_dwordx4 v[76:79], v30, s[16:19], s42 offen
    s_add_u32 s42, s41, 786432
    buffer_load_dwordx4 v[80:83], v30, s[16:19], s42 offen
    s_add_u32 s42, s41, 851968
    buffer_load_dwordx4 v[84:87], v30, s[16:19], s42 offen
    v_mov_b32 v96, 0
    v_mov_b32 v97, 0
    v_mov_b32 v98, 0
    v_mov_b32 v99, 0
    v_mov_b32 v100, 0
    v_mov_b32 v101, 0
    v_mov_b32 v102, 0
    v_mov_b32 v103, 0
    v_mov_b32 v104, 0
    v_mov_b32 v105, 0
    v_mov_b32 v106, 0
    v_mov_b32 v107, 0
    v_mov_b32 v108, 0
    v_mov_b32 v109, 0
    v_mov_b32 v110, 0
    v_mov_b32 v111, 0
    ds_read_b32 v24, v7 offset:0
    ds_read_b32 v25, v7 offset:1792
    s_waitcnt vmcnt(13) lgkmcnt(0)
    v_lshlrev_b32 v28, 16, v32
    v_and_b32 v29, 0xffff0000, v32
    v_fmac_f32 v96, v24, v28
    v_fmac_f32 v97, v24, v29
    v_fmac_f32 v104, v25, v28
    v_fmac_f32 v105, v25, v29
    v_lshlrev_b32 v28, 16, v33
    v_and_b32 v29, 0xffff0000, v33
    v_fmac_f32 v98, v24, v28
    v_fmac_f32 v99, v24, v29
    v_fmac_f32 v106, v25, v28
    v_fmac_f32 v107, v25, v29
    v_lshlrev_b32 v28, 16, v34
    v_and_b32 v29, 0xffff0000, v34
    v_fmac_f32 v100, v24, v28
    v_fmac_f32 v101, v24, v29
    v_fmac_f32 v108, v25, v28
    v_fmac_f32 v109, v25, v29
    v_lshlrev_b32 v28, 16, v35
    v_and_b32 v29, 0xffff0000, v35
    v_fmac_f32 v102, v24, v28
    v_fmac_f32 v103, v24, v29
    v_fmac_f32 v110, v25, v28
    v_fmac_f32 v111, v25, v29
    ds_read_b32 v24, v7 offset:32
    ds_read_b32 v25, v7 offset:1824
    s_waitcnt vmcnt(12) lgkmcnt(0)
    v_lshlrev_b32 v28, 16, v36
    v_and_b32 v29, 0xffff0000, v36
    v_fmac_f32 v96, v24, v28
    v_fmac_f32 v97, v24, v29
    v_fmac_f32 v104, v25, v28
    v_fmac_f32 v105, v25, v29
    v_lshlrev_b32 v28, 16, v37
    v_and_b32 v29, 0xffff0000, v37
    v_fmac_f32 v98, v24, v28
    v_fmac_f32 v99, v24, v29
    v_fmac_f32 v106, v25, v28
    v_fmac_f32 v107, v25, v29
    v_lshlrev_b32 v28, 16, v38
    v_and_b32 v29, 0xffff0000, v38
    v_fmac_f32 v100, v24, v28
    v_fmac_f32 v101, v24, v29
    v_fmac_f32 v108, v25, v28
    v_fmac_f32 v109, v25, v29
    v_lshlrev_b32 v28, 16, v39
    v_and_b32 v29, 0xffff0000, v39
    v_fmac_f32 v102, v24, v28
    v_fmac_f32 v103, v24, v29
    v_fmac_f32 v110, v25, v28
    v_fmac_f32 v111, v25, v29
    ds_read_b32 v24, v7 offset:64
    ds_read_b32 v25, v7 offset:1856
    s_waitcnt vmcnt(11) lgkmcnt(0)
    v_lshlrev_b32 v28, 16, v40
    v_and_b32 v29, 0xffff0000, v40
    v_fmac_f32 v96, v24, v28
    v_fmac_f32 v97, v24, v29
    v_fmac_f32 v104, v25, v28
    v_fmac_f32 v105, v25, v29
    v_lshlrev_b32 v28, 16, v41
    v_and_b32 v29, 0xffff0000, v41
    v_fmac_f32 v98, v24, v28
    v_fmac_f32 v99, v24, v29
    v_fmac_f32 v106, v25, v28
    v_fmac_f32 v107, v25, v29
    v_lshlrev_b32 v28, 16, v42
    v_and_b32 v29, 0xffff0000, v42
    v_fmac_f32 v100, v24, v28
    v_fmac_f32 v101, v24, v29
    v_fmac_f32 v108, v25, v28
    v_fmac_f32 v109, v25, v29
    v_lshlrev_b32 v28, 16, v43
    v_and_b32 v29, 0xffff0000, v43
    v_fmac_f32 v102, v24, v28
    v_fmac_f32 v103, v24, v29
    v_fmac_f32 v110, v25, v28
    v_fmac_f32 v111, v25, v29
    ds_read_b32 v24, v7 offset:96
    ds_read_b32 v25, v7 offset:1888
    s_waitcnt vmcnt(10) lgkmcnt(0)
    v_lshlrev_b32 v28, 16, v44
    v_and_b32 v29, 0xffff0000, v44
    v_fmac_f32 v96, v24, v28
    v_fmac_f32 v97, v24, v29
    v_fmac_f32 v104, v25, v28
    v_fmac_f32 v105, v25, v29
    v_lshlrev_b32 v28, 16, v45
    v_and_b32 v29, 0xffff0000, v45
    v_fmac_f32 v98, v24, v28
    v_fmac_f32 v99, v24, v29
    v_fmac_f32 v106, v25, v28
    v_fmac_f32 v107, v25, v29
    v_lshlrev_b32 v28, 16, v46
    v_and_b32 v29, 0xffff0000, v46
    v_fmac_f32 v100, v24, v28
    v_fmac_f32 v101, v24, v29
    v_fmac_f32 v108, v25, v28
    v_fmac_f32 v109, v25, v29
    v_lshlrev_b32 v28, 16, v47
    v_and_b32 v29, 0xffff0000, v47
    v_fmac_f32 v102, v24, v28
    v_fmac_f32 v103, v24, v29
    v_fmac_f32 v110, v25, v28
    v_fmac_f32 v111, v25, v29
    ds_read_b32 v24, v7 offset:128
    ds_read_b32 v25, v7 offset:1920
    s_waitcnt vmcnt(9) lgkmcnt(0)
    v_lshlrev_b32 v28, 16, v48
    v_and_b32 v29, 0xffff0000, v48
    v_fmac_f32 v96, v24, v28
    v_fmac_f32 v97, v24, v29
    v_fmac_f32 v104, v25, v28
    v_fmac_f32 v105, v25, v29
    v_lshlrev_b32 v28, 16, v49
    v_and_b32 v29, 0xffff0000, v49
    v_fmac_f32 v98, v24, v28
    v_fmac_f32 v99, v24, v29
    v_fmac_f32 v106, v25, v28
    v_fmac_f32 v107, v25, v29
    v_lshlrev_b32 v28, 16, v50
    v_and_b32 v29, 0xffff0000, v50
    v_fmac_f32 v100, v24, v28
    v_fmac_f32 v101, v24, v29
    v_fmac_f32 v108, v25, v28
    v_fmac_f32 v109, v25, v29
    v_lshlrev_b32 v28, 16, v51
    v_and_b32 v29, 0xffff0000, v51
    v_fmac_f32 v102, v24, v28
    v_fmac_f32 v103, v24, v29
    v_fmac_f32 v110, v25, v28
    v_fmac_f32 v111, v25, v29
    ds_read_b32 v24, v7 offset:160
    ds_read_b32 v25, v7 offset:1952
    s_waitcnt vmcnt(8) lgkmcnt(0)
    v_lshlrev_b32 v28, 16, v52
    v_and_b32 v29, 0xffff0000, v52
    v_fmac_f32 v96, v24, v28
    v_fmac_f32 v97, v24, v29
    v_fmac_f32 v104, v25, v28
    v_fmac_f32 v105, v25, v29
    v_lshlrev_b32 v28, 16, v53
    v_and_b32 v29, 0xffff0000, v53
    v_fmac_f32 v98, v24, v28
    v_fmac_f32 v99, v24, v29
    v_fmac_f32 v106, v25, v28
    v_fmac_f32 v107, v25, v29
    v_lshlrev_b32 v28, 16, v54
    v_and_b32 v29, 0xffff0000, v54
    v_fmac_f32 v100, v24, v28
    v_fmac_f32 v101, v24, v29
    v_fmac_f32 v108, v25, v28
    v_fmac_f32 v109, v25, v29
    v_lshlrev_b32 v28, 16, v55
    v_and_b32 v29, 0xffff0000, v55
    v_fmac_f32 v102, v24, v28
    v_fmac_f32 v103, v24, v29
    v_fmac_f32 v110, v25, v28
    v_fmac_f32 v111, v25, v29
    ds_read_b32 v24, v7 offset:192
    ds_read_b32 v25, v7 offset:1984
    s_waitcnt vmcnt(7) lgkmcnt(0)
    v_lshlrev_b32 v28, 16, v56
    v_and_b32 v29, 0xffff0000, v56
    v_fmac_f32 v96, v24, v28
    v_fmac_f32 v97, v24, v29
    v_fmac_f32 v104, v25, v28
    v_fmac_f32 v105, v25, v29
    v_lshlrev_b32 v28, 16, v57
    v_and_b32 v29, 0xffff0000, v57
    v_fmac_f32 v98, v24, v28
    v_fmac_f32 v99, v24, v29
    v_fmac_f32 v106, v25, v28
    v_fmac_f32 v107, v25, v29
    v_lshlrev_b32 v28, 16, v58
    v_and_b32 v29, 0xffff0000, v58
    v_fmac_f32 v100, v24, v28
    v_fmac_f32 v101, v24, v29
    v_fmac_f32 v108, v25, v28
    v_fmac_f32 v109, v25, v29
    v_lshlrev_b32 v28, 16, v59
    v_and_b32 v29, 0xffff0000, v59
    v_fmac_f32 v102, v24, v28
    v_fmac_f32 v103, v24, v29
    v_fmac_f32 v110, v25, v28
    v_fmac_f32 v111, v25, v29
    ds_read_b32 v24, v7 offset:224
    ds_read_b32 v25, v7 offset:2016
    s_waitcnt vmcnt(6) lgkmcnt(0)
    v_lshlrev_b32 v28, 16, v60
    v_and_b32 v29, 0xffff0000, v60
    v_fmac_f32 v96, v24, v28
    v_fmac_f32 v97, v24, v29
    v_fmac_f32 v104, v25, v28
    v_fmac_f32 v105, v25, v29
    v_lshlrev_b32 v28, 16, v61
    v_and_b32 v29, 0xffff0000, v61
    v_fmac_f32 v98, v24, v28
    v_fmac_f32 v99, v24, v29
    v_fmac_f32 v106, v25, v28
    v_fmac_f32 v107, v25, v29
    v_lshlrev_b32 v28, 16, v62
    v_and_b32 v29, 0xffff0000, v62
    v_fmac_f32 v100, v24, v28
    v_fmac_f32 v101, v24, v29
    v_fmac_f32 v108, v25, v28
    v_fmac_f32 v109, v25, v29
    v_lshlrev_b32 v28, 16, v63
    v_and_b32 v29, 0xffff0000, v63
    v_fmac_f32 v102, v24, v28
    v_fmac_f32 v103, v24, v29
    v_fmac_f32 v110, v25, v28
    v_fmac_f32 v111, v25, v29
    ds_read_b32 v24, v7 offset:256
    ds_read_b32 v25, v7 offset:2048
    s_waitcnt vmcnt(5) lgkmcnt(0)
    v_lshlrev_b32 v28, 16, v64
    v_and_b32 v29, 0xffff0000, v64
    v_fmac_f32 v96, v24, v28
    v_fmac_f32 v97, v24, v29
    v_fmac_f32 v104, v25, v28
    v_fmac_f32 v105, v25, v29
    v_lshlrev_b32 v28, 16, v65
    v_and_b32 v29, 0xffff0000, v65
    v_fmac_f32 v98, v24, v28
    v_fmac_f32 v99, v24, v29
    v_fmac_f32 v106, v25, v28
    v_fmac_f32 v107, v25, v29
    v_lshlrev_b32 v28, 16, v66
    v_and_b32 v29, 0xffff0000, v66
    v_fmac_f32 v100, v24, v28
    v_fmac_f32 v101, v24, v29
    v_fmac_f32 v108, v25, v28
    v_fmac_f32 v109, v25, v29
    v_lshlrev_b32 v28, 16, v67
    v_and_b32 v29, 0xffff0000, v67
    v_fmac_f32 v102, v24, v28
    v_fmac_f32 v103, v24, v29
    v_fmac_f32 v110, v25, v28
    v_fmac_f32 v111, v25, v29
    ds_read_b32 v24, v7 offset:288
    ds_read_b32 v25, v7 offset:2080
    s_waitcnt vmcnt(4) lgkmcnt(0)
    v_lshlrev_b32 v28, 16, v68
    v_and_b32 v29, 0xffff0000, v68
    v_fmac_f32 v96, v24, v28
    v_fmac_f32 v97, v24, v29
    v_fmac_f32 v104, v25, v28
    v_fmac_f32 v105, v25, v29
    v_lshlrev_b32 v28, 16, v69
    v_and_b32 v29, 0xffff0000, v69
    v_fmac_f32 v98, v24, v28
    v_fmac_f32 v99, v24, v29
    v_fmac_f32 v106, v25, v28
    v_fmac_f32 v107, v25, v29
    v_lshlrev_b32 v28, 16, v70
    v_and_b32 v29, 0xffff0000, v70
    v_fmac_f32 v100, v24, v28
    v_fmac_f32 v101, v24, v29
    v_fmac_f32 v108, v25, v28
    v_fmac_f32 v109, v25, v29
    v_lshlrev_b32 v28, 16, v71
    v_and_b32 v29, 0xffff0000, v71
    v_fmac_f32 v102, v24, v28
    v_fmac_f32 v103, v24, v29
    v_fmac_f32 v110, v25, v28
    v_fmac_f32 v111, v25, v29
    ds_read_b32 v24, v7 offset:320
    ds_read_b32 v25, v7 offset:2112
    s_waitcnt vmcnt(3) lgkmcnt(0)
    v_lshlrev_b32 v28, 16, v72
    v_and_b32 v29, 0xffff0000, v72
    v_fmac_f32 v96, v24, v28
    v_fmac_f32 v97, v24, v29
    v_fmac_f32 v104, v25, v28
    v_fmac_f32 v105, v25, v29
    v_lshlrev_b32 v28, 16, v73
    v_and_b32 v29, 0xffff0000, v73
    v_fmac_f32 v98, v24, v28
    v_fmac_f32 v99, v24, v29
    v_fmac_f32 v106, v25, v28
    v_fmac_f32 v107, v25, v29
    v_lshlrev_b32 v28, 16, v74
    v_and_b32 v29, 0xffff0000, v74
    v_fmac_f32 v100, v24, v28
    v_fmac_f32 v101, v24, v29
    v_fmac_f32 v108, v25, v28
    v_fmac_f32 v109, v25, v29
    v_lshlrev_b32 v28, 16, v75
    v_and_b32 v29, 0xffff0000, v75
    v_fmac_f32 v102, v24, v28
    v_fmac_f32 v103, v24, v29
    v_fmac_f32 v110, v25, v28
    v_fmac_f32 v111, v25, v29
    ds_read_b32 v24, v7 offset:352
    ds_read_b32 v25, v7 offset:2144
    s_waitcnt vmcnt(2) lgkmcnt(0)
    v_lshlrev_b32 v28, 16, v76
    v_and_b32 v29, 0xffff0000, v76
    v_fmac_f32 v96, v24, v28
    v_fmac_f32 v97, v24, v29
    v_fmac_f32 v104, v25, v28
    v_fmac_f32 v105, v25, v29
    v_lshlrev_b32 v28, 16, v77
    v_and_b32 v29, 0xffff0000, v77
    v_fmac_f32 v98, v24, v28
    v_fmac_f32 v99, v24, v29
    v_fmac_f32 v106, v25, v28
    v_fmac_f32 v107, v25, v29
    v_lshlrev_b32 v28, 16, v78
    v_and_b32 v29, 0xffff0000, v78
    v_fmac_f32 v100, v24, v28
    v_fmac_f32 v101, v24, v29
    v_fmac_f32 v108, v25, v28
    v_fmac_f32 v109, v25, v29
    v_lshlrev_b32 v28, 16, v79
    v_and_b32 v29, 0xffff0000, v79
    v_fmac_f32 v102, v24, v28
    v_fmac_f32 v103, v24, v29
    v_fmac_f32 v110, v25, v28
    v_fmac_f32 v111, v25, v29
    ds_read_b32 v24, v7 offset:384
    ds_read_b32 v25, v7 offset:2176
    s_waitcnt vmcnt(1) lgkmcnt(0)
    v_lshlrev_b32 v28, 16, v80
    v_and_b32 v29, 0xffff0000, v80
    v_fmac_f32 v96, v24, v28
    v_fmac_f32 v97, v24, v29
    v_fmac_f32 v104, v25, v28
    v_fmac_f32 v105, v25, v29
    v_lshlrev_b32 v28, 16, v81
    v_and_b32 v29, 0xffff0000, v81
    v_fmac_f32 v98, v24, v28
    v_fmac_f32 v99, v24, v29
    v_fmac_f32 v106, v25, v28
    v_fmac_f32 v107, v25, v29
    v_lshlrev_b32 v28, 16, v82
    v_and_b32 v29, 0xffff0000, v82
    v_fmac_f32 v100, v24, v28
    v_fmac_f32 v101, v24, v29
    v_fmac_f32 v108, v25, v28
    v_fmac_f32 v109, v25, v29
    v_lshlrev_b32 v28, 16, v83
    v_and_b32 v29, 0xffff0000, v83
    v_fmac_f32 v102, v24, v28
    v_fmac_f32 v103, v24, v29
    v_fmac_f32 v110, v25, v28
    v_fmac_f32 v111, v25, v29
    ds_read_b32 v24, v7 offset:416
    ds_read_b32 v25, v7 offset:2208
    s_waitcnt vmcnt(0) lgkmcnt(0)
    v_lshlrev_b32 v28, 16, v84
    v_and_b32 v29, 0xffff0000, v84
    v_fmac_f32 v96, v24, v28
    v_fmac_f32 v97, v24, v29
    v_fmac_f32 v104, v25, v28
    v_fmac_f32 v105, v25, v29
    v_lshlrev_b32 v28, 16, v85
    v_and_b32 v29, 0xffff0000, v85
    v_fmac_f32 v98, v24, v28
    v_fmac_f32 v99, v24, v29
    v_fmac_f32 v106, v25, v28
    v_fmac_f32 v107, v25, v29
    v_lshlrev_b32 v28, 16, v86
    v_and_b32 v29, 0xffff0000, v86
    v_fmac_f32 v100, v24, v28
    v_fmac_f32 v101, v24, v29
    v_fmac_f32 v108, v25, v28
    v_fmac_f32 v109, v25, v29
    v_lshlrev_b32 v28, 16, v87
    v_and_b32 v29, 0xffff0000, v87
    v_fmac_f32 v102, v24, v28
    v_fmac_f32 v103, v24, v29
    v_fmac_f32 v110, v25, v28
    v_fmac_f32 v111, v25, v29
    v_lshlrev_b32 v26, 3, v2
    v_add_u32 v26, v26, v4
    v_lshlrev_b32 v26, 9, v26
    v_lshlrev_b32 v27, 1, v6
    v_add_u32 v26, v26, v27
    ds_write_b128 v26, v[96:99] offset:4096
    ds_write_b128 v26, v[100:103] offset:4112
    ds_write_b128 v26, v[104:107] offset:4352
    ds_write_b128 v26, v[108:111] offset:4368
    s_waitcnt lgkmcnt(0)
    s_barrier
    v_cmp_gt_u32 vcc, 128, v0
    s_and_saveexec_b64 s[44:45], vcc
    s_cbranch_execz K1_END
    v_lshlrev_b32 v26, 2, v0
    v_mov_b32 v27, 0
    ds_read_b32 v32, v26 offset:4096
    ds_read_b32 v33, v26 offset:4608
    ds_read_b32 v34, v26 offset:5120
    ds_read_b32 v35, v26 offset:5632
    ds_read_b32 v36, v26 offset:6144
    ds_read_b32 v37, v26 offset:6656
    ds_read_b32 v38, v26 offset:7168
    ds_read_b32 v39, v26 offset:7680
    ds_read_b32 v40, v26 offset:8192
    ds_read_b32 v41, v26 offset:8704
    ds_read_b32 v42, v26 offset:9216
    ds_read_b32 v43, v26 offset:9728
    ds_read_b32 v44, v26 offset:10240
    ds_read_b32 v45, v26 offset:10752
    ds_read_b32 v46, v26 offset:11264
    ds_read_b32 v47, v26 offset:11776
    ds_read_b32 v48, v26 offset:12288
    ds_read_b32 v49, v26 offset:12800
    ds_read_b32 v50, v26 offset:13312
    ds_read_b32 v51, v26 offset:13824
    ds_read_b32 v52, v26 offset:14336
    ds_read_b32 v53, v26 offset:14848
    ds_read_b32 v54, v26 offset:15360
    ds_read_b32 v55, v26 offset:15872
    ds_read_b32 v56, v26 offset:16384
    ds_read_b32 v57, v26 offset:16896
    ds_read_b32 v58, v26 offset:17408
    ds_read_b32 v59, v26 offset:17920
    ds_read_b32 v60, v26 offset:18432
    ds_read_b32 v61, v26 offset:18944
    ds_read_b32 v62, v26 offset:19456
    ds_read_b32 v63, v26 offset:19968
    s_waitcnt lgkmcnt(0)
    v_add_f32 v27, v27, v32
    v_add_f32 v27, v27, v33
    v_add_f32 v27, v27, v34
    v_add_f32 v27, v27, v35
    v_add_f32 v27, v27, v36
    v_add_f32 v27, v27, v37
    v_add_f32 v27, v27, v38
    v_add_f32 v27, v27, v39
    v_add_f32 v27, v27, v40
    v_add_f32 v27, v27, v41
    v_add_f32 v27, v27, v42
    v_add_f32 v27, v27, v43
    v_add_f32 v27, v27, v44
    v_add_f32 v27, v27, v45
    v_add_f32 v27, v27, v46
    v_add_f32 v27, v27, v47
    v_add_f32 v27, v27, v48
    v_add_f32 v27, v27, v49
    v_add_f32 v27, v27, v50
    v_add_f32 v27, v27, v51
    v_add_f32 v27, v27, v52
    v_add_f32 v27, v27, v53
    v_add_f32 v27, v27, v54
    v_add_f32 v27, v27, v55
    v_add_f32 v27, v27, v56
    v_add_f32 v27, v27, v57
    v_add_f32 v27, v27, v58
    v_add_f32 v27, v27, v59
    v_add_f32 v27, v27, v60
    v_add_f32 v27, v27, v61
    v_add_f32 v27, v27, v62
    v_add_f32 v27, v27, v63
    v_cvt_pk_bf16_f32 v27, v27, v27
    v_lshrrev_b32 v28, 6, v0
    v_lshlrev_b32 v28, 13, v28
    v_and_b32 v29, 63, v0
    v_lshlrev_b32 v29, 1, v29
    v_add_u32 v28, v28, v29
    buffer_store_short v27, v28, s[32:35], s41 offen offset:0
    s_branch K1_END
K1_FFN:
    s_sub_u32 s41, s2, 64
    s_lshl_b32 s41, s41, 7
    v_mul_u32_u24 v30, 3584, v5
    v_add_u32 v30, v30, v6
    s_add_u32 s42, s41, 0
    buffer_load_dwordx4 v[32:35], v30, s[20:23], s42 offen
    buffer_load_dwordx4 v[128:131], v30, s[24:27], s42 offen
    s_add_u32 s42, s41, 28672
    buffer_load_dwordx4 v[36:39], v30, s[20:23], s42 offen
    buffer_load_dwordx4 v[132:135], v30, s[24:27], s42 offen
    s_add_u32 s42, s41, 57344
    buffer_load_dwordx4 v[40:43], v30, s[20:23], s42 offen
    buffer_load_dwordx4 v[136:139], v30, s[24:27], s42 offen
    s_add_u32 s42, s41, 86016
    buffer_load_dwordx4 v[44:47], v30, s[20:23], s42 offen
    buffer_load_dwordx4 v[140:143], v30, s[24:27], s42 offen
    s_add_u32 s42, s41, 114688
    buffer_load_dwordx4 v[48:51], v30, s[20:23], s42 offen
    buffer_load_dwordx4 v[144:147], v30, s[24:27], s42 offen
    s_add_u32 s42, s41, 143360
    buffer_load_dwordx4 v[52:55], v30, s[20:23], s42 offen
    buffer_load_dwordx4 v[148:151], v30, s[24:27], s42 offen
    s_add_u32 s42, s41, 172032
    buffer_load_dwordx4 v[56:59], v30, s[20:23], s42 offen
    buffer_load_dwordx4 v[152:155], v30, s[24:27], s42 offen
    s_add_u32 s42, s41, 200704
    buffer_load_dwordx4 v[60:63], v30, s[20:23], s42 offen
    buffer_load_dwordx4 v[156:159], v30, s[24:27], s42 offen
    s_add_u32 s42, s41, 229376
    buffer_load_dwordx4 v[64:67], v30, s[20:23], s42 offen
    buffer_load_dwordx4 v[160:163], v30, s[24:27], s42 offen
    s_add_u32 s42, s41, 258048
    buffer_load_dwordx4 v[68:71], v30, s[20:23], s42 offen
    buffer_load_dwordx4 v[164:167], v30, s[24:27], s42 offen
    s_add_u32 s42, s41, 286720
    buffer_load_dwordx4 v[72:75], v30, s[20:23], s42 offen
    buffer_load_dwordx4 v[168:171], v30, s[24:27], s42 offen
    s_add_u32 s42, s41, 315392
    buffer_load_dwordx4 v[76:79], v30, s[20:23], s42 offen
    buffer_load_dwordx4 v[172:175], v30, s[24:27], s42 offen
    s_add_u32 s42, s41, 344064
    buffer_load_dwordx4 v[80:83], v30, s[20:23], s42 offen
    buffer_load_dwordx4 v[176:179], v30, s[24:27], s42 offen
    s_add_u32 s42, s41, 372736
    buffer_load_dwordx4 v[84:87], v30, s[20:23], s42 offen
    buffer_load_dwordx4 v[180:183], v30, s[24:27], s42 offen
    v_mov_b32 v96, 0
    v_mov_b32 v97, 0
    v_mov_b32 v98, 0
    v_mov_b32 v99, 0
    v_mov_b32 v100, 0
    v_mov_b32 v101, 0
    v_mov_b32 v102, 0
    v_mov_b32 v103, 0
    v_mov_b32 v104, 0
    v_mov_b32 v105, 0
    v_mov_b32 v106, 0
    v_mov_b32 v107, 0
    v_mov_b32 v108, 0
    v_mov_b32 v109, 0
    v_mov_b32 v110, 0
    v_mov_b32 v111, 0
    v_mov_b32 v112, 0
    v_mov_b32 v113, 0
    v_mov_b32 v114, 0
    v_mov_b32 v115, 0
    v_mov_b32 v116, 0
    v_mov_b32 v117, 0
    v_mov_b32 v118, 0
    v_mov_b32 v119, 0
    v_mov_b32 v120, 0
    v_mov_b32 v121, 0
    v_mov_b32 v122, 0
    v_mov_b32 v123, 0
    v_mov_b32 v124, 0
    v_mov_b32 v125, 0
    v_mov_b32 v126, 0
    v_mov_b32 v127, 0
    ds_read_b32 v24, v7 offset:0
    ds_read_b32 v25, v7 offset:1792
    s_waitcnt vmcnt(26) lgkmcnt(0)
    v_lshlrev_b32 v28, 16, v32
    v_and_b32 v29, 0xffff0000, v32
    v_fmac_f32 v96, v24, v28
    v_fmac_f32 v97, v24, v29
    v_fmac_f32 v104, v25, v28
    v_fmac_f32 v105, v25, v29
    v_lshlrev_b32 v28, 16, v33
    v_and_b32 v29, 0xffff0000, v33
    v_fmac_f32 v98, v24, v28
    v_fmac_f32 v99, v24, v29
    v_fmac_f32 v106, v25, v28
    v_fmac_f32 v107, v25, v29
    v_lshlrev_b32 v28, 16, v34
    v_and_b32 v29, 0xffff0000, v34
    v_fmac_f32 v100, v24, v28
    v_fmac_f32 v101, v24, v29
    v_fmac_f32 v108, v25, v28
    v_fmac_f32 v109, v25, v29
    v_lshlrev_b32 v28, 16, v35
    v_and_b32 v29, 0xffff0000, v35
    v_fmac_f32 v102, v24, v28
    v_fmac_f32 v103, v24, v29
    v_fmac_f32 v110, v25, v28
    v_fmac_f32 v111, v25, v29
    v_lshlrev_b32 v28, 16, v128
    v_and_b32 v29, 0xffff0000, v128
    v_fmac_f32 v112, v24, v28
    v_fmac_f32 v113, v24, v29
    v_fmac_f32 v120, v25, v28
    v_fmac_f32 v121, v25, v29
    v_lshlrev_b32 v28, 16, v129
    v_and_b32 v29, 0xffff0000, v129
    v_fmac_f32 v114, v24, v28
    v_fmac_f32 v115, v24, v29
    v_fmac_f32 v122, v25, v28
    v_fmac_f32 v123, v25, v29
    v_lshlrev_b32 v28, 16, v130
    v_and_b32 v29, 0xffff0000, v130
    v_fmac_f32 v116, v24, v28
    v_fmac_f32 v117, v24, v29
    v_fmac_f32 v124, v25, v28
    v_fmac_f32 v125, v25, v29
    v_lshlrev_b32 v28, 16, v131
    v_and_b32 v29, 0xffff0000, v131
    v_fmac_f32 v118, v24, v28
    v_fmac_f32 v119, v24, v29
    v_fmac_f32 v126, v25, v28
    v_fmac_f32 v127, v25, v29
    ds_read_b32 v24, v7 offset:32
    ds_read_b32 v25, v7 offset:1824
    s_waitcnt vmcnt(24) lgkmcnt(0)
    v_lshlrev_b32 v28, 16, v36
    v_and_b32 v29, 0xffff0000, v36
    v_fmac_f32 v96, v24, v28
    v_fmac_f32 v97, v24, v29
    v_fmac_f32 v104, v25, v28
    v_fmac_f32 v105, v25, v29
    v_lshlrev_b32 v28, 16, v37
    v_and_b32 v29, 0xffff0000, v37
    v_fmac_f32 v98, v24, v28
    v_fmac_f32 v99, v24, v29
    v_fmac_f32 v106, v25, v28
    v_fmac_f32 v107, v25, v29
    v_lshlrev_b32 v28, 16, v38
    v_and_b32 v29, 0xffff0000, v38
    v_fmac_f32 v100, v24, v28
    v_fmac_f32 v101, v24, v29
    v_fmac_f32 v108, v25, v28
    v_fmac_f32 v109, v25, v29
    v_lshlrev_b32 v28, 16, v39
    v_and_b32 v29, 0xffff0000, v39
    v_fmac_f32 v102, v24, v28
    v_fmac_f32 v103, v24, v29
    v_fmac_f32 v110, v25, v28
    v_fmac_f32 v111, v25, v29
    v_lshlrev_b32 v28, 16, v132
    v_and_b32 v29, 0xffff0000, v132
    v_fmac_f32 v112, v24, v28
    v_fmac_f32 v113, v24, v29
    v_fmac_f32 v120, v25, v28
    v_fmac_f32 v121, v25, v29
    v_lshlrev_b32 v28, 16, v133
    v_and_b32 v29, 0xffff0000, v133
    v_fmac_f32 v114, v24, v28
    v_fmac_f32 v115, v24, v29
    v_fmac_f32 v122, v25, v28
    v_fmac_f32 v123, v25, v29
    v_lshlrev_b32 v28, 16, v134
    v_and_b32 v29, 0xffff0000, v134
    v_fmac_f32 v116, v24, v28
    v_fmac_f32 v117, v24, v29
    v_fmac_f32 v124, v25, v28
    v_fmac_f32 v125, v25, v29
    v_lshlrev_b32 v28, 16, v135
    v_and_b32 v29, 0xffff0000, v135
    v_fmac_f32 v118, v24, v28
    v_fmac_f32 v119, v24, v29
    v_fmac_f32 v126, v25, v28
    v_fmac_f32 v127, v25, v29
    ds_read_b32 v24, v7 offset:64
    ds_read_b32 v25, v7 offset:1856
    s_waitcnt vmcnt(22) lgkmcnt(0)
    v_lshlrev_b32 v28, 16, v40
    v_and_b32 v29, 0xffff0000, v40
    v_fmac_f32 v96, v24, v28
    v_fmac_f32 v97, v24, v29
    v_fmac_f32 v104, v25, v28
    v_fmac_f32 v105, v25, v29
    v_lshlrev_b32 v28, 16, v41
    v_and_b32 v29, 0xffff0000, v41
    v_fmac_f32 v98, v24, v28
    v_fmac_f32 v99, v24, v29
    v_fmac_f32 v106, v25, v28
    v_fmac_f32 v107, v25, v29
    v_lshlrev_b32 v28, 16, v42
    v_and_b32 v29, 0xffff0000, v42
    v_fmac_f32 v100, v24, v28
    v_fmac_f32 v101, v24, v29
    v_fmac_f32 v108, v25, v28
    v_fmac_f32 v109, v25, v29
    v_lshlrev_b32 v28, 16, v43
    v_and_b32 v29, 0xffff0000, v43
    v_fmac_f32 v102, v24, v28
    v_fmac_f32 v103, v24, v29
    v_fmac_f32 v110, v25, v28
    v_fmac_f32 v111, v25, v29
    v_lshlrev_b32 v28, 16, v136
    v_and_b32 v29, 0xffff0000, v136
    v_fmac_f32 v112, v24, v28
    v_fmac_f32 v113, v24, v29
    v_fmac_f32 v120, v25, v28
    v_fmac_f32 v121, v25, v29
    v_lshlrev_b32 v28, 16, v137
    v_and_b32 v29, 0xffff0000, v137
    v_fmac_f32 v114, v24, v28
    v_fmac_f32 v115, v24, v29
    v_fmac_f32 v122, v25, v28
    v_fmac_f32 v123, v25, v29
    v_lshlrev_b32 v28, 16, v138
    v_and_b32 v29, 0xffff0000, v138
    v_fmac_f32 v116, v24, v28
    v_fmac_f32 v117, v24, v29
    v_fmac_f32 v124, v25, v28
    v_fmac_f32 v125, v25, v29
    v_lshlrev_b32 v28, 16, v139
    v_and_b32 v29, 0xffff0000, v139
    v_fmac_f32 v118, v24, v28
    v_fmac_f32 v119, v24, v29
    v_fmac_f32 v126, v25, v28
    v_fmac_f32 v127, v25, v29
    ds_read_b32 v24, v7 offset:96
    ds_read_b32 v25, v7 offset:1888
    s_waitcnt vmcnt(20) lgkmcnt(0)
    v_lshlrev_b32 v28, 16, v44
    v_and_b32 v29, 0xffff0000, v44
    v_fmac_f32 v96, v24, v28
    v_fmac_f32 v97, v24, v29
    v_fmac_f32 v104, v25, v28
    v_fmac_f32 v105, v25, v29
    v_lshlrev_b32 v28, 16, v45
    v_and_b32 v29, 0xffff0000, v45
    v_fmac_f32 v98, v24, v28
    v_fmac_f32 v99, v24, v29
    v_fmac_f32 v106, v25, v28
    v_fmac_f32 v107, v25, v29
    v_lshlrev_b32 v28, 16, v46
    v_and_b32 v29, 0xffff0000, v46
    v_fmac_f32 v100, v24, v28
    v_fmac_f32 v101, v24, v29
    v_fmac_f32 v108, v25, v28
    v_fmac_f32 v109, v25, v29
    v_lshlrev_b32 v28, 16, v47
    v_and_b32 v29, 0xffff0000, v47
    v_fmac_f32 v102, v24, v28
    v_fmac_f32 v103, v24, v29
    v_fmac_f32 v110, v25, v28
    v_fmac_f32 v111, v25, v29
    v_lshlrev_b32 v28, 16, v140
    v_and_b32 v29, 0xffff0000, v140
    v_fmac_f32 v112, v24, v28
    v_fmac_f32 v113, v24, v29
    v_fmac_f32 v120, v25, v28
    v_fmac_f32 v121, v25, v29
    v_lshlrev_b32 v28, 16, v141
    v_and_b32 v29, 0xffff0000, v141
    v_fmac_f32 v114, v24, v28
    v_fmac_f32 v115, v24, v29
    v_fmac_f32 v122, v25, v28
    v_fmac_f32 v123, v25, v29
    v_lshlrev_b32 v28, 16, v142
    v_and_b32 v29, 0xffff0000, v142
    v_fmac_f32 v116, v24, v28
    v_fmac_f32 v117, v24, v29
    v_fmac_f32 v124, v25, v28
    v_fmac_f32 v125, v25, v29
    v_lshlrev_b32 v28, 16, v143
    v_and_b32 v29, 0xffff0000, v143
    v_fmac_f32 v118, v24, v28
    v_fmac_f32 v119, v24, v29
    v_fmac_f32 v126, v25, v28
    v_fmac_f32 v127, v25, v29
    ds_read_b32 v24, v7 offset:128
    ds_read_b32 v25, v7 offset:1920
    s_waitcnt vmcnt(18) lgkmcnt(0)
    v_lshlrev_b32 v28, 16, v48
    v_and_b32 v29, 0xffff0000, v48
    v_fmac_f32 v96, v24, v28
    v_fmac_f32 v97, v24, v29
    v_fmac_f32 v104, v25, v28
    v_fmac_f32 v105, v25, v29
    v_lshlrev_b32 v28, 16, v49
    v_and_b32 v29, 0xffff0000, v49
    v_fmac_f32 v98, v24, v28
    v_fmac_f32 v99, v24, v29
    v_fmac_f32 v106, v25, v28
    v_fmac_f32 v107, v25, v29
    v_lshlrev_b32 v28, 16, v50
    v_and_b32 v29, 0xffff0000, v50
    v_fmac_f32 v100, v24, v28
    v_fmac_f32 v101, v24, v29
    v_fmac_f32 v108, v25, v28
    v_fmac_f32 v109, v25, v29
    v_lshlrev_b32 v28, 16, v51
    v_and_b32 v29, 0xffff0000, v51
    v_fmac_f32 v102, v24, v28
    v_fmac_f32 v103, v24, v29
    v_fmac_f32 v110, v25, v28
    v_fmac_f32 v111, v25, v29
    v_lshlrev_b32 v28, 16, v144
    v_and_b32 v29, 0xffff0000, v144
    v_fmac_f32 v112, v24, v28
    v_fmac_f32 v113, v24, v29
    v_fmac_f32 v120, v25, v28
    v_fmac_f32 v121, v25, v29
    v_lshlrev_b32 v28, 16, v145
    v_and_b32 v29, 0xffff0000, v145
    v_fmac_f32 v114, v24, v28
    v_fmac_f32 v115, v24, v29
    v_fmac_f32 v122, v25, v28
    v_fmac_f32 v123, v25, v29
    v_lshlrev_b32 v28, 16, v146
    v_and_b32 v29, 0xffff0000, v146
    v_fmac_f32 v116, v24, v28
    v_fmac_f32 v117, v24, v29
    v_fmac_f32 v124, v25, v28
    v_fmac_f32 v125, v25, v29
    v_lshlrev_b32 v28, 16, v147
    v_and_b32 v29, 0xffff0000, v147
    v_fmac_f32 v118, v24, v28
    v_fmac_f32 v119, v24, v29
    v_fmac_f32 v126, v25, v28
    v_fmac_f32 v127, v25, v29
    ds_read_b32 v24, v7 offset:160
    ds_read_b32 v25, v7 offset:1952
    s_waitcnt vmcnt(16) lgkmcnt(0)
    v_lshlrev_b32 v28, 16, v52
    v_and_b32 v29, 0xffff0000, v52
    v_fmac_f32 v96, v24, v28
    v_fmac_f32 v97, v24, v29
    v_fmac_f32 v104, v25, v28
    v_fmac_f32 v105, v25, v29
    v_lshlrev_b32 v28, 16, v53
    v_and_b32 v29, 0xffff0000, v53
    v_fmac_f32 v98, v24, v28
    v_fmac_f32 v99, v24, v29
    v_fmac_f32 v106, v25, v28
    v_fmac_f32 v107, v25, v29
    v_lshlrev_b32 v28, 16, v54
    v_and_b32 v29, 0xffff0000, v54
    v_fmac_f32 v100, v24, v28
    v_fmac_f32 v101, v24, v29
    v_fmac_f32 v108, v25, v28
    v_fmac_f32 v109, v25, v29
    v_lshlrev_b32 v28, 16, v55
    v_and_b32 v29, 0xffff0000, v55
    v_fmac_f32 v102, v24, v28
    v_fmac_f32 v103, v24, v29
    v_fmac_f32 v110, v25, v28
    v_fmac_f32 v111, v25, v29
    v_lshlrev_b32 v28, 16, v148
    v_and_b32 v29, 0xffff0000, v148
    v_fmac_f32 v112, v24, v28
    v_fmac_f32 v113, v24, v29
    v_fmac_f32 v120, v25, v28
    v_fmac_f32 v121, v25, v29
    v_lshlrev_b32 v28, 16, v149
    v_and_b32 v29, 0xffff0000, v149
    v_fmac_f32 v114, v24, v28
    v_fmac_f32 v115, v24, v29
    v_fmac_f32 v122, v25, v28
    v_fmac_f32 v123, v25, v29
    v_lshlrev_b32 v28, 16, v150
    v_and_b32 v29, 0xffff0000, v150
    v_fmac_f32 v116, v24, v28
    v_fmac_f32 v117, v24, v29
    v_fmac_f32 v124, v25, v28
    v_fmac_f32 v125, v25, v29
    v_lshlrev_b32 v28, 16, v151
    v_and_b32 v29, 0xffff0000, v151
    v_fmac_f32 v118, v24, v28
    v_fmac_f32 v119, v24, v29
    v_fmac_f32 v126, v25, v28
    v_fmac_f32 v127, v25, v29
    ds_read_b32 v24, v7 offset:192
    ds_read_b32 v25, v7 offset:1984
    s_waitcnt vmcnt(14) lgkmcnt(0)
    v_lshlrev_b32 v28, 16, v56
    v_and_b32 v29, 0xffff0000, v56
    v_fmac_f32 v96, v24, v28
    v_fmac_f32 v97, v24, v29
    v_fmac_f32 v104, v25, v28
    v_fmac_f32 v105, v25, v29
    v_lshlrev_b32 v28, 16, v57
    v_and_b32 v29, 0xffff0000, v57
    v_fmac_f32 v98, v24, v28
    v_fmac_f32 v99, v24, v29
    v_fmac_f32 v106, v25, v28
    v_fmac_f32 v107, v25, v29
    v_lshlrev_b32 v28, 16, v58
    v_and_b32 v29, 0xffff0000, v58
    v_fmac_f32 v100, v24, v28
    v_fmac_f32 v101, v24, v29
    v_fmac_f32 v108, v25, v28
    v_fmac_f32 v109, v25, v29
    v_lshlrev_b32 v28, 16, v59
    v_and_b32 v29, 0xffff0000, v59
    v_fmac_f32 v102, v24, v28
    v_fmac_f32 v103, v24, v29
    v_fmac_f32 v110, v25, v28
    v_fmac_f32 v111, v25, v29
    v_lshlrev_b32 v28, 16, v152
    v_and_b32 v29, 0xffff0000, v152
    v_fmac_f32 v112, v24, v28
    v_fmac_f32 v113, v24, v29
    v_fmac_f32 v120, v25, v28
    v_fmac_f32 v121, v25, v29
    v_lshlrev_b32 v28, 16, v153
    v_and_b32 v29, 0xffff0000, v153
    v_fmac_f32 v114, v24, v28
    v_fmac_f32 v115, v24, v29
    v_fmac_f32 v122, v25, v28
    v_fmac_f32 v123, v25, v29
    v_lshlrev_b32 v28, 16, v154
    v_and_b32 v29, 0xffff0000, v154
    v_fmac_f32 v116, v24, v28
    v_fmac_f32 v117, v24, v29
    v_fmac_f32 v124, v25, v28
    v_fmac_f32 v125, v25, v29
    v_lshlrev_b32 v28, 16, v155
    v_and_b32 v29, 0xffff0000, v155
    v_fmac_f32 v118, v24, v28
    v_fmac_f32 v119, v24, v29
    v_fmac_f32 v126, v25, v28
    v_fmac_f32 v127, v25, v29
    ds_read_b32 v24, v7 offset:224
    ds_read_b32 v25, v7 offset:2016
    s_waitcnt vmcnt(12) lgkmcnt(0)
    v_lshlrev_b32 v28, 16, v60
    v_and_b32 v29, 0xffff0000, v60
    v_fmac_f32 v96, v24, v28
    v_fmac_f32 v97, v24, v29
    v_fmac_f32 v104, v25, v28
    v_fmac_f32 v105, v25, v29
    v_lshlrev_b32 v28, 16, v61
    v_and_b32 v29, 0xffff0000, v61
    v_fmac_f32 v98, v24, v28
    v_fmac_f32 v99, v24, v29
    v_fmac_f32 v106, v25, v28
    v_fmac_f32 v107, v25, v29
    v_lshlrev_b32 v28, 16, v62
    v_and_b32 v29, 0xffff0000, v62
    v_fmac_f32 v100, v24, v28
    v_fmac_f32 v101, v24, v29
    v_fmac_f32 v108, v25, v28
    v_fmac_f32 v109, v25, v29
    v_lshlrev_b32 v28, 16, v63
    v_and_b32 v29, 0xffff0000, v63
    v_fmac_f32 v102, v24, v28
    v_fmac_f32 v103, v24, v29
    v_fmac_f32 v110, v25, v28
    v_fmac_f32 v111, v25, v29
    v_lshlrev_b32 v28, 16, v156
    v_and_b32 v29, 0xffff0000, v156
    v_fmac_f32 v112, v24, v28
    v_fmac_f32 v113, v24, v29
    v_fmac_f32 v120, v25, v28
    v_fmac_f32 v121, v25, v29
    v_lshlrev_b32 v28, 16, v157
    v_and_b32 v29, 0xffff0000, v157
    v_fmac_f32 v114, v24, v28
    v_fmac_f32 v115, v24, v29
    v_fmac_f32 v122, v25, v28
    v_fmac_f32 v123, v25, v29
    v_lshlrev_b32 v28, 16, v158
    v_and_b32 v29, 0xffff0000, v158
    v_fmac_f32 v116, v24, v28
    v_fmac_f32 v117, v24, v29
    v_fmac_f32 v124, v25, v28
    v_fmac_f32 v125, v25, v29
    v_lshlrev_b32 v28, 16, v159
    v_and_b32 v29, 0xffff0000, v159
    v_fmac_f32 v118, v24, v28
    v_fmac_f32 v119, v24, v29
    v_fmac_f32 v126, v25, v28
    v_fmac_f32 v127, v25, v29
    ds_read_b32 v24, v7 offset:256
    ds_read_b32 v25, v7 offset:2048
    s_waitcnt vmcnt(10) lgkmcnt(0)
    v_lshlrev_b32 v28, 16, v64
    v_and_b32 v29, 0xffff0000, v64
    v_fmac_f32 v96, v24, v28
    v_fmac_f32 v97, v24, v29
    v_fmac_f32 v104, v25, v28
    v_fmac_f32 v105, v25, v29
    v_lshlrev_b32 v28, 16, v65
    v_and_b32 v29, 0xffff0000, v65
    v_fmac_f32 v98, v24, v28
    v_fmac_f32 v99, v24, v29
    v_fmac_f32 v106, v25, v28
    v_fmac_f32 v107, v25, v29
    v_lshlrev_b32 v28, 16, v66
    v_and_b32 v29, 0xffff0000, v66
    v_fmac_f32 v100, v24, v28
    v_fmac_f32 v101, v24, v29
    v_fmac_f32 v108, v25, v28
    v_fmac_f32 v109, v25, v29
    v_lshlrev_b32 v28, 16, v67
    v_and_b32 v29, 0xffff0000, v67
    v_fmac_f32 v102, v24, v28
    v_fmac_f32 v103, v24, v29
    v_fmac_f32 v110, v25, v28
    v_fmac_f32 v111, v25, v29
    v_lshlrev_b32 v28, 16, v160
    v_and_b32 v29, 0xffff0000, v160
    v_fmac_f32 v112, v24, v28
    v_fmac_f32 v113, v24, v29
    v_fmac_f32 v120, v25, v28
    v_fmac_f32 v121, v25, v29
    v_lshlrev_b32 v28, 16, v161
    v_and_b32 v29, 0xffff0000, v161
    v_fmac_f32 v114, v24, v28
    v_fmac_f32 v115, v24, v29
    v_fmac_f32 v122, v25, v28
    v_fmac_f32 v123, v25, v29
    v_lshlrev_b32 v28, 16, v162
    v_and_b32 v29, 0xffff0000, v162
    v_fmac_f32 v116, v24, v28
    v_fmac_f32 v117, v24, v29
    v_fmac_f32 v124, v25, v28
    v_fmac_f32 v125, v25, v29
    v_lshlrev_b32 v28, 16, v163
    v_and_b32 v29, 0xffff0000, v163
    v_fmac_f32 v118, v24, v28
    v_fmac_f32 v119, v24, v29
    v_fmac_f32 v126, v25, v28
    v_fmac_f32 v127, v25, v29
    ds_read_b32 v24, v7 offset:288
    ds_read_b32 v25, v7 offset:2080
    s_waitcnt vmcnt(8) lgkmcnt(0)
    v_lshlrev_b32 v28, 16, v68
    v_and_b32 v29, 0xffff0000, v68
    v_fmac_f32 v96, v24, v28
    v_fmac_f32 v97, v24, v29
    v_fmac_f32 v104, v25, v28
    v_fmac_f32 v105, v25, v29
    v_lshlrev_b32 v28, 16, v69
    v_and_b32 v29, 0xffff0000, v69
    v_fmac_f32 v98, v24, v28
    v_fmac_f32 v99, v24, v29
    v_fmac_f32 v106, v25, v28
    v_fmac_f32 v107, v25, v29
    v_lshlrev_b32 v28, 16, v70
    v_and_b32 v29, 0xffff0000, v70
    v_fmac_f32 v100, v24, v28
    v_fmac_f32 v101, v24, v29
    v_fmac_f32 v108, v25, v28
    v_fmac_f32 v109, v25, v29
    v_lshlrev_b32 v28, 16, v71
    v_and_b32 v29, 0xffff0000, v71
    v_fmac_f32 v102, v24, v28
    v_fmac_f32 v103, v24, v29
    v_fmac_f32 v110, v25, v28
    v_fmac_f32 v111, v25, v29
    v_lshlrev_b32 v28, 16, v164
    v_and_b32 v29, 0xffff0000, v164
    v_fmac_f32 v112, v24, v28
    v_fmac_f32 v113, v24, v29
    v_fmac_f32 v120, v25, v28
    v_fmac_f32 v121, v25, v29
    v_lshlrev_b32 v28, 16, v165
    v_and_b32 v29, 0xffff0000, v165
    v_fmac_f32 v114, v24, v28
    v_fmac_f32 v115, v24, v29
    v_fmac_f32 v122, v25, v28
    v_fmac_f32 v123, v25, v29
    v_lshlrev_b32 v28, 16, v166
    v_and_b32 v29, 0xffff0000, v166
    v_fmac_f32 v116, v24, v28
    v_fmac_f32 v117, v24, v29
    v_fmac_f32 v124, v25, v28
    v_fmac_f32 v125, v25, v29
    v_lshlrev_b32 v28, 16, v167
    v_and_b32 v29, 0xffff0000, v167
    v_fmac_f32 v118, v24, v28
    v_fmac_f32 v119, v24, v29
    v_fmac_f32 v126, v25, v28
    v_fmac_f32 v127, v25, v29
    ds_read_b32 v24, v7 offset:320
    ds_read_b32 v25, v7 offset:2112
    s_waitcnt vmcnt(6) lgkmcnt(0)
    v_lshlrev_b32 v28, 16, v72
    v_and_b32 v29, 0xffff0000, v72
    v_fmac_f32 v96, v24, v28
    v_fmac_f32 v97, v24, v29
    v_fmac_f32 v104, v25, v28
    v_fmac_f32 v105, v25, v29
    v_lshlrev_b32 v28, 16, v73
    v_and_b32 v29, 0xffff0000, v73
    v_fmac_f32 v98, v24, v28
    v_fmac_f32 v99, v24, v29
    v_fmac_f32 v106, v25, v28
    v_fmac_f32 v107, v25, v29
    v_lshlrev_b32 v28, 16, v74
    v_and_b32 v29, 0xffff0000, v74
    v_fmac_f32 v100, v24, v28
    v_fmac_f32 v101, v24, v29
    v_fmac_f32 v108, v25, v28
    v_fmac_f32 v109, v25, v29
    v_lshlrev_b32 v28, 16, v75
    v_and_b32 v29, 0xffff0000, v75
    v_fmac_f32 v102, v24, v28
    v_fmac_f32 v103, v24, v29
    v_fmac_f32 v110, v25, v28
    v_fmac_f32 v111, v25, v29
    v_lshlrev_b32 v28, 16, v168
    v_and_b32 v29, 0xffff0000, v168
    v_fmac_f32 v112, v24, v28
    v_fmac_f32 v113, v24, v29
    v_fmac_f32 v120, v25, v28
    v_fmac_f32 v121, v25, v29
    v_lshlrev_b32 v28, 16, v169
    v_and_b32 v29, 0xffff0000, v169
    v_fmac_f32 v114, v24, v28
    v_fmac_f32 v115, v24, v29
    v_fmac_f32 v122, v25, v28
    v_fmac_f32 v123, v25, v29
    v_lshlrev_b32 v28, 16, v170
    v_and_b32 v29, 0xffff0000, v170
    v_fmac_f32 v116, v24, v28
    v_fmac_f32 v117, v24, v29
    v_fmac_f32 v124, v25, v28
    v_fmac_f32 v125, v25, v29
    v_lshlrev_b32 v28, 16, v171
    v_and_b32 v29, 0xffff0000, v171
    v_fmac_f32 v118, v24, v28
    v_fmac_f32 v119, v24, v29
    v_fmac_f32 v126, v25, v28
    v_fmac_f32 v127, v25, v29
    ds_read_b32 v24, v7 offset:352
    ds_read_b32 v25, v7 offset:2144
    s_waitcnt vmcnt(4) lgkmcnt(0)
    v_lshlrev_b32 v28, 16, v76
    v_and_b32 v29, 0xffff0000, v76
    v_fmac_f32 v96, v24, v28
    v_fmac_f32 v97, v24, v29
    v_fmac_f32 v104, v25, v28
    v_fmac_f32 v105, v25, v29
    v_lshlrev_b32 v28, 16, v77
    v_and_b32 v29, 0xffff0000, v77
    v_fmac_f32 v98, v24, v28
    v_fmac_f32 v99, v24, v29
    v_fmac_f32 v106, v25, v28
    v_fmac_f32 v107, v25, v29
    v_lshlrev_b32 v28, 16, v78
    v_and_b32 v29, 0xffff0000, v78
    v_fmac_f32 v100, v24, v28
    v_fmac_f32 v101, v24, v29
    v_fmac_f32 v108, v25, v28
    v_fmac_f32 v109, v25, v29
    v_lshlrev_b32 v28, 16, v79
    v_and_b32 v29, 0xffff0000, v79
    v_fmac_f32 v102, v24, v28
    v_fmac_f32 v103, v24, v29
    v_fmac_f32 v110, v25, v28
    v_fmac_f32 v111, v25, v29
    v_lshlrev_b32 v28, 16, v172
    v_and_b32 v29, 0xffff0000, v172
    v_fmac_f32 v112, v24, v28
    v_fmac_f32 v113, v24, v29
    v_fmac_f32 v120, v25, v28
    v_fmac_f32 v121, v25, v29
    v_lshlrev_b32 v28, 16, v173
    v_and_b32 v29, 0xffff0000, v173
    v_fmac_f32 v114, v24, v28
    v_fmac_f32 v115, v24, v29
    v_fmac_f32 v122, v25, v28
    v_fmac_f32 v123, v25, v29
    v_lshlrev_b32 v28, 16, v174
    v_and_b32 v29, 0xffff0000, v174
    v_fmac_f32 v116, v24, v28
    v_fmac_f32 v117, v24, v29
    v_fmac_f32 v124, v25, v28
    v_fmac_f32 v125, v25, v29
    v_lshlrev_b32 v28, 16, v175
    v_and_b32 v29, 0xffff0000, v175
    v_fmac_f32 v118, v24, v28
    v_fmac_f32 v119, v24, v29
    v_fmac_f32 v126, v25, v28
    v_fmac_f32 v127, v25, v29
    ds_read_b32 v24, v7 offset:384
    ds_read_b32 v25, v7 offset:2176
    s_waitcnt vmcnt(2) lgkmcnt(0)
    v_lshlrev_b32 v28, 16, v80
    v_and_b32 v29, 0xffff0000, v80
    v_fmac_f32 v96, v24, v28
    v_fmac_f32 v97, v24, v29
    v_fmac_f32 v104, v25, v28
    v_fmac_f32 v105, v25, v29
    v_lshlrev_b32 v28, 16, v81
    v_and_b32 v29, 0xffff0000, v81
    v_fmac_f32 v98, v24, v28
    v_fmac_f32 v99, v24, v29
    v_fmac_f32 v106, v25, v28
    v_fmac_f32 v107, v25, v29
    v_lshlrev_b32 v28, 16, v82
    v_and_b32 v29, 0xffff0000, v82
    v_fmac_f32 v100, v24, v28
    v_fmac_f32 v101, v24, v29
    v_fmac_f32 v108, v25, v28
    v_fmac_f32 v109, v25, v29
    v_lshlrev_b32 v28, 16, v83
    v_and_b32 v29, 0xffff0000, v83
    v_fmac_f32 v102, v24, v28
    v_fmac_f32 v103, v24, v29
    v_fmac_f32 v110, v25, v28
    v_fmac_f32 v111, v25, v29
    v_lshlrev_b32 v28, 16, v176
    v_and_b32 v29, 0xffff0000, v176
    v_fmac_f32 v112, v24, v28
    v_fmac_f32 v113, v24, v29
    v_fmac_f32 v120, v25, v28
    v_fmac_f32 v121, v25, v29
    v_lshlrev_b32 v28, 16, v177
    v_and_b32 v29, 0xffff0000, v177
    v_fmac_f32 v114, v24, v28
    v_fmac_f32 v115, v24, v29
    v_fmac_f32 v122, v25, v28
    v_fmac_f32 v123, v25, v29
    v_lshlrev_b32 v28, 16, v178
    v_and_b32 v29, 0xffff0000, v178
    v_fmac_f32 v116, v24, v28
    v_fmac_f32 v117, v24, v29
    v_fmac_f32 v124, v25, v28
    v_fmac_f32 v125, v25, v29
    v_lshlrev_b32 v28, 16, v179
    v_and_b32 v29, 0xffff0000, v179
    v_fmac_f32 v118, v24, v28
    v_fmac_f32 v119, v24, v29
    v_fmac_f32 v126, v25, v28
    v_fmac_f32 v127, v25, v29
    ds_read_b32 v24, v7 offset:416
    ds_read_b32 v25, v7 offset:2208
    s_waitcnt vmcnt(0) lgkmcnt(0)
    v_lshlrev_b32 v28, 16, v84
    v_and_b32 v29, 0xffff0000, v84
    v_fmac_f32 v96, v24, v28
    v_fmac_f32 v97, v24, v29
    v_fmac_f32 v104, v25, v28
    v_fmac_f32 v105, v25, v29
    v_lshlrev_b32 v28, 16, v85
    v_and_b32 v29, 0xffff0000, v85
    v_fmac_f32 v98, v24, v28
    v_fmac_f32 v99, v24, v29
    v_fmac_f32 v106, v25, v28
    v_fmac_f32 v107, v25, v29
    v_lshlrev_b32 v28, 16, v86
    v_and_b32 v29, 0xffff0000, v86
    v_fmac_f32 v100, v24, v28
    v_fmac_f32 v101, v24, v29
    v_fmac_f32 v108, v25, v28
    v_fmac_f32 v109, v25, v29
    v_lshlrev_b32 v28, 16, v87
    v_and_b32 v29, 0xffff0000, v87
    v_fmac_f32 v102, v24, v28
    v_fmac_f32 v103, v24, v29
    v_fmac_f32 v110, v25, v28
    v_fmac_f32 v111, v25, v29
    v_lshlrev_b32 v28, 16, v180
    v_and_b32 v29, 0xffff0000, v180
    v_fmac_f32 v112, v24, v28
    v_fmac_f32 v113, v24, v29
    v_fmac_f32 v120, v25, v28
    v_fmac_f32 v121, v25, v29
    v_lshlrev_b32 v28, 16, v181
    v_and_b32 v29, 0xffff0000, v181
    v_fmac_f32 v114, v24, v28
    v_fmac_f32 v115, v24, v29
    v_fmac_f32 v122, v25, v28
    v_fmac_f32 v123, v25, v29
    v_lshlrev_b32 v28, 16, v182
    v_and_b32 v29, 0xffff0000, v182
    v_fmac_f32 v116, v24, v28
    v_fmac_f32 v117, v24, v29
    v_fmac_f32 v124, v25, v28
    v_fmac_f32 v125, v25, v29
    v_lshlrev_b32 v28, 16, v183
    v_and_b32 v29, 0xffff0000, v183
    v_fmac_f32 v118, v24, v28
    v_fmac_f32 v119, v24, v29
    v_fmac_f32 v126, v25, v28
    v_fmac_f32 v127, v25, v29
    v_lshlrev_b32 v26, 3, v2
    v_add_u32 v26, v26, v4
    v_lshlrev_b32 v26, 9, v26
    v_lshlrev_b32 v27, 1, v6
    v_add_u32 v26, v26, v27
    ds_write_b128 v26, v[96:99] offset:4096
    ds_write_b128 v26, v[100:103] offset:4112
    ds_write_b128 v26, v[104:107] offset:4352
    ds_write_b128 v26, v[108:111] offset:4368
    ds_write_b128 v26, v[112:115] offset:20480
    ds_write_b128 v26, v[116:119] offset:20496
    ds_write_b128 v26, v[120:123] offset:20736
    ds_write_b128 v26, v[124:127] offset:20752
    s_waitcnt lgkmcnt(0)
    s_barrier
    v_cmp_gt_u32 vcc, 128, v0
    s_and_saveexec_b64 s[44:45], vcc
    s_cbranch_execz K1_END
    v_lshlrev_b32 v26, 2, v0
    v_mov_b32 v27, 0
    v_mov_b32 v31, 0
    ds_read_b32 v32, v26 offset:4096
    ds_read_b32 v64, v26 offset:20480
    ds_read_b32 v33, v26 offset:4608
    ds_read_b32 v65, v26 offset:20992
    ds_read_b32 v34, v26 offset:5120
    ds_read_b32 v66, v26 offset:21504
    ds_read_b32 v35, v26 offset:5632
    ds_read_b32 v67, v26 offset:22016
    ds_read_b32 v36, v26 offset:6144
    ds_read_b32 v68, v26 offset:22528
    ds_read_b32 v37, v26 offset:6656
    ds_read_b32 v69, v26 offset:23040
    ds_read_b32 v38, v26 offset:7168
    ds_read_b32 v70, v26 offset:23552
    ds_read_b32 v39, v26 offset:7680
    ds_read_b32 v71, v26 offset:24064
    ds_read_b32 v40, v26 offset:8192
    ds_read_b32 v72, v26 offset:24576
    ds_read_b32 v41, v26 offset:8704
    ds_read_b32 v73, v26 offset:25088
    ds_read_b32 v42, v26 offset:9216
    ds_read_b32 v74, v26 offset:25600
    ds_read_b32 v43, v26 offset:9728
    ds_read_b32 v75, v26 offset:26112
    ds_read_b32 v44, v26 offset:10240
    ds_read_b32 v76, v26 offset:26624
    ds_read_b32 v45, v26 offset:10752
    ds_read_b32 v77, v26 offset:27136
    ds_read_b32 v46, v26 offset:11264
    ds_read_b32 v78, v26 offset:27648
    ds_read_b32 v47, v26 offset:11776
    ds_read_b32 v79, v26 offset:28160
    ds_read_b32 v48, v26 offset:12288
    ds_read_b32 v80, v26 offset:28672
    ds_read_b32 v49, v26 offset:12800
    ds_read_b32 v81, v26 offset:29184
    ds_read_b32 v50, v26 offset:13312
    ds_read_b32 v82, v26 offset:29696
    ds_read_b32 v51, v26 offset:13824
    ds_read_b32 v83, v26 offset:30208
    ds_read_b32 v52, v26 offset:14336
    ds_read_b32 v84, v26 offset:30720
    ds_read_b32 v53, v26 offset:14848
    ds_read_b32 v85, v26 offset:31232
    ds_read_b32 v54, v26 offset:15360
    ds_read_b32 v86, v26 offset:31744
    ds_read_b32 v55, v26 offset:15872
    ds_read_b32 v87, v26 offset:32256
    ds_read_b32 v56, v26 offset:16384
    ds_read_b32 v88, v26 offset:32768
    ds_read_b32 v57, v26 offset:16896
    ds_read_b32 v89, v26 offset:33280
    ds_read_b32 v58, v26 offset:17408
    ds_read_b32 v90, v26 offset:33792
    ds_read_b32 v59, v26 offset:17920
    ds_read_b32 v91, v26 offset:34304
    ds_read_b32 v60, v26 offset:18432
    ds_read_b32 v92, v26 offset:34816
    ds_read_b32 v61, v26 offset:18944
    ds_read_b32 v93, v26 offset:35328
    ds_read_b32 v62, v26 offset:19456
    ds_read_b32 v94, v26 offset:35840
    ds_read_b32 v63, v26 offset:19968
    ds_read_b32 v95, v26 offset:36352
    s_waitcnt lgkmcnt(0)
    v_add_f32 v27, v27, v32
    v_add_f32 v31, v31, v64
    v_add_f32 v27, v27, v33
    v_add_f32 v31, v31, v65
    v_add_f32 v27, v27, v34
    v_add_f32 v31, v31, v66
    v_add_f32 v27, v27, v35
    v_add_f32 v31, v31, v67
    v_add_f32 v27, v27, v36
    v_add_f32 v31, v31, v68
    v_add_f32 v27, v27, v37
    v_add_f32 v31, v31, v69
    v_add_f32 v27, v27, v38
    v_add_f32 v31, v31, v70
    v_add_f32 v27, v27, v39
    v_add_f32 v31, v31, v71
    v_add_f32 v27, v27, v40
    v_add_f32 v31, v31, v72
    v_add_f32 v27, v27, v41
    v_add_f32 v31, v31, v73
    v_add_f32 v27, v27, v42
    v_add_f32 v31, v31, v74
    v_add_f32 v27, v27, v43
    v_add_f32 v31, v31, v75
    v_add_f32 v27, v27, v44
    v_add_f32 v31, v31, v76
    v_add_f32 v27, v27, v45
    v_add_f32 v31, v31, v77
    v_add_f32 v27, v27, v46
    v_add_f32 v31, v31, v78
    v_add_f32 v27, v27, v47
    v_add_f32 v31, v31, v79
    v_add_f32 v27, v27, v48
    v_add_f32 v31, v31, v80
    v_add_f32 v27, v27, v49
    v_add_f32 v31, v31, v81
    v_add_f32 v27, v27, v50
    v_add_f32 v31, v31, v82
    v_add_f32 v27, v27, v51
    v_add_f32 v31, v31, v83
    v_add_f32 v27, v27, v52
    v_add_f32 v31, v31, v84
    v_add_f32 v27, v27, v53
    v_add_f32 v31, v31, v85
    v_add_f32 v27, v27, v54
    v_add_f32 v31, v31, v86
    v_add_f32 v27, v27, v55
    v_add_f32 v31, v31, v87
    v_add_f32 v27, v27, v56
    v_add_f32 v31, v31, v88
    v_add_f32 v27, v27, v57
    v_add_f32 v31, v31, v89
    v_add_f32 v27, v27, v58
    v_add_f32 v31, v31, v90
    v_add_f32 v27, v27, v59
    v_add_f32 v31, v31, v91
    v_add_f32 v27, v27, v60
    v_add_f32 v31, v31, v92
    v_add_f32 v27, v27, v61
    v_add_f32 v31, v31, v93
    v_add_f32 v27, v27, v62
    v_add_f32 v31, v31, v94
    v_add_f32 v27, v27, v63
    v_add_f32 v31, v31, v95
    v_cvt_pk_bf16_f32 v27, v27, v27
    v_lshlrev_b32 v27, 16, v27
    v_cvt_pk_bf16_f32 v31, v31, v31
    v_lshlrev_b32 v31, 16, v31
    v_mul_f32 v28, v27, v27
    v_mul_f32 v28, 0x3d372713, v28
    v_add_f32 v28, 1.0, v28
    v_mul_f32 v28, v28, v27
    v_mul_f32 v28, 0x40135761, v28
    v_exp_f32 v28, v28
    s_nop 0
    v_add_f32 v28, 1.0, v28
    v_rcp_f32 v28, v28
    s_nop 0
    v_sub_f32 v28, 1.0, v28
    v_mul_f32 v28, v28, v27
    v_cvt_pk_bf16_f32 v28, v28, v28
    v_lshlrev_b32 v28, 16, v28
    v_mul_f32 v28, v28, v31
    v_cvt_pk_bf16_f32 v27, v28, v28
    v_lshrrev_b32 v28, 6, v0
    v_mul_u32_u24 v28, 3584, v28
    v_and_b32 v29, 63, v0
    v_lshlrev_b32 v29, 1, v29
    v_add_u32 v28, v28, v29
    s_add_u32 s41, s41, 16384
    buffer_store_short v27, v28, s[32:35], s41 offen
K1_END:
    s_endpgm
.globl attn_kernel
.p2align 8
.type attn_kernel,@function
attn_kernel:
    s_cmp_ge_u32 s2, 1024
    s_cbranch_scc1 K2_END
    s_load_dwordx2 s[4:5], s[0:1], 8
    s_load_dwordx2 s[6:7], s[0:1], 16
    s_load_dwordx2 s[8:9], s[0:1], 88
    v_and_b32 v1, 63, v0
    v_lshrrev_b32 v4, 6, v0
    s_nop 0
    v_readfirstlane_b32 s24, v4
    s_lshr_b32 s27, s2, 6
    s_and_b32 s28, s2, 63
    s_waitcnt lgkmcnt(0)
    s_mov_b32 s12, s4
    s_and_b32 s13, s5, 0xffff
    s_mov_b32 s14, 0x10000000
    s_mov_b32 s15, 0x00020000
    s_mov_b32 s16, s6
    s_and_b32 s17, s7, 0xffff
    s_mov_b32 s18, 0x10000000
    s_mov_b32 s19, 0x00020000
    s_mov_b32 s20, s8
    s_and_b32 s21, s9, 0xffff
    s_mov_b32 s22, 0x40000000
    s_mov_b32 s23, 0x00020000
    s_mul_i32 s25, s2, 262144
    s_mul_i32 s26, s24, 65536
    s_add_u32 s25, s25, s26
    v_and_b32 v5, 15, v1
    v_lshrrev_b32 v6, 4, v1
    v_lshlrev_b32 v6, 4, v6
    v_lshlrev_b32 v2, 9, v5
    v_add_u32 v2, v2, v6
    v_lshlrev_b32 v3, 4, v1
    s_mov_b32 s26, s25
    buffer_load_dwordx4 v[48:51], v2, s[12:15], s26 offen offset:0 nt
    buffer_load_dwordx4 v[52:55], v2, s[12:15], s26 offen offset:64 nt
    buffer_load_dwordx4 v[56:59], v2, s[12:15], s26 offen offset:128 nt
    buffer_load_dwordx4 v[60:63], v2, s[12:15], s26 offen offset:192 nt
    buffer_load_dwordx4 v[64:67], v2, s[12:15], s26 offen offset:256 nt
    buffer_load_dwordx4 v[68:71], v2, s[12:15], s26 offen offset:320 nt
    buffer_load_dwordx4 v[72:75], v2, s[12:15], s26 offen offset:384 nt
    buffer_load_dwordx4 v[76:79], v2, s[12:15], s26 offen offset:448 nt
    v_mov_b32 v16, 0
    v_mov_b32 v17, 0
    v_mov_b32 v18, 0
    v_mov_b32 v19, 0
    v_mov_b32 v20, 0
    v_mov_b32 v21, 0
    v_mov_b32 v22, 0
    v_mov_b32 v23, 0
    v_mov_b32 v24, 0
    v_mov_b32 v25, 0
    v_mov_b32 v26, 0
    v_mov_b32 v27, 0
    v_mov_b32 v28, 0
    v_mov_b32 v29, 0
    v_mov_b32 v30, 0
    v_mov_b32 v31, 0
    v_mov_b32 v32, 0
    v_mov_b32 v33, 0
    v_mov_b32 v34, 0
    v_mov_b32 v35, 0
    v_mov_b32 v36, 0
    v_mov_b32 v37, 0
    v_mov_b32 v38, 0
    v_mov_b32 v39, 0
    v_mov_b32 v40, 0
    v_mov_b32 v41, 0
    v_mov_b32 v42, 0
    v_mov_b32 v43, 0
    v_mov_b32 v44, 0
    v_mov_b32 v45, 0
    v_mov_b32 v46, 0
    v_mov_b32 v47, 0
    s_lshl_b32 s29, s27, 10
    v_cmp_gt_u32 vcc, 2, v5
    s_and_saveexec_b64 s[30:31], vcc
    buffer_load_dwordx4 v[16:19], v2, s[20:23], s29 offen offset:0
    buffer_load_dwordx4 v[20:23], v2, s[20:23], s29 offen offset:64
    buffer_load_dwordx4 v[24:27], v2, s[20:23], s29 offen offset:128
    buffer_load_dwordx4 v[28:31], v2, s[20:23], s29 offen offset:192
    buffer_load_dwordx4 v[32:35], v2, s[20:23], s29 offen offset:256
    buffer_load_dwordx4 v[36:39], v2, s[20:23], s29 offen offset:320
    buffer_load_dwordx4 v[40:43], v2, s[20:23], s29 offen offset:384
    buffer_load_dwordx4 v[44:47], v2, s[20:23], s29 offen offset:448
    s_mov_b64 exec, s[30:31]
    s_add_u32 s26, s25, 8192
    buffer_load_dwordx4 v[80:83], v2, s[12:15], s26 offen offset:0 nt
    buffer_load_dwordx4 v[84:87], v2, s[12:15], s26 offen offset:64 nt
    buffer_load_dwordx4 v[88:91], v2, s[12:15], s26 offen offset:128 nt
    buffer_load_dwordx4 v[92:95], v2, s[12:15], s26 offen offset:192 nt
    buffer_load_dwordx4 v[96:99], v2, s[12:15], s26 offen offset:256 nt
    buffer_load_dwordx4 v[100:103], v2, s[12:15], s26 offen offset:320 nt
    buffer_load_dwordx4 v[104:107], v2, s[12:15], s26 offen offset:384 nt
    buffer_load_dwordx4 v[108:111], v2, s[12:15], s26 offen offset:448 nt
    s_waitcnt vmcnt(8)
    v_mfma_f32_16x16x32_bf16 v[112:115], v[16:19], v[48:51], 0
    v_mfma_f32_16x16x32_bf16 v[112:115], v[20:23], v[52:55], v[112:115]
    v_mfma_f32_16x16x32_bf16 v[112:115], v[24:27], v[56:59], v[112:115]
    v_mfma_f32_16x16x32_bf16 v[112:115], v[28:31], v[60:63], v[112:115]
    v_mfma_f32_16x16x32_bf16 v[112:115], v[32:35], v[64:67], v[112:115]
    v_mfma_f32_16x16x32_bf16 v[112:115], v[36:39], v[68:71], v[112:115]
    v_mfma_f32_16x16x32_bf16 v[112:115], v[40:43], v[72:75], v[112:115]
    v_mfma_f32_16x16x32_bf16 v[112:115], v[44:47], v[76:79], v[112:115]
    s_add_u32 s26, s25, 16384
    buffer_load_dwordx4 v[48:51], v2, s[12:15], s26 offen offset:0 nt
    buffer_load_dwordx4 v[52:55], v2, s[12:15], s26 offen offset:64 nt
    buffer_load_dwordx4 v[56:59], v2, s[12:15], s26 offen offset:128 nt
    buffer_load_dwordx4 v[60:63], v2, s[12:15], s26 offen offset:192 nt
    buffer_load_dwordx4 v[64:67], v2, s[12:15], s26 offen offset:256 nt
    buffer_load_dwordx4 v[68:71], v2, s[12:15], s26 offen offset:320 nt
    buffer_load_dwordx4 v[72:75], v2, s[12:15], s26 offen offset:384 nt
    buffer_load_dwordx4 v[76:79], v2, s[12:15], s26 offen offset:448 nt
    s_waitcnt vmcnt(8)
    v_mfma_f32_16x16x32_bf16 v[116:119], v[16:19], v[80:83], 0
    v_mfma_f32_16x16x32_bf16 v[116:119], v[20:23], v[84:87], v[116:119]
    v_mfma_f32_16x16x32_bf16 v[116:119], v[24:27], v[88:91], v[116:119]
    v_mfma_f32_16x16x32_bf16 v[116:119], v[28:31], v[92:95], v[116:119]
    v_mfma_f32_16x16x32_bf16 v[116:119], v[32:35], v[96:99], v[116:119]
    v_mfma_f32_16x16x32_bf16 v[116:119], v[36:39], v[100:103], v[116:119]
    v_mfma_f32_16x16x32_bf16 v[116:119], v[40:43], v[104:107], v[116:119]
    v_mfma_f32_16x16x32_bf16 v[116:119], v[44:47], v[108:111], v[116:119]
    s_add_u32 s26, s25, 24576
    buffer_load_dwordx4 v[80:83], v2, s[12:15], s26 offen offset:0 nt
    buffer_load_dwordx4 v[84:87], v2, s[12:15], s26 offen offset:64 nt
    buffer_load_dwordx4 v[88:91], v2, s[12:15], s26 offen offset:128 nt
    buffer_load_dwordx4 v[92:95], v2, s[12:15], s26 offen offset:192 nt
    buffer_load_dwordx4 v[96:99], v2, s[12:15], s26 offen offset:256 nt
    buffer_load_dwordx4 v[100:103], v2, s[12:15], s26 offen offset:320 nt
    buffer_load_dwordx4 v[104:107], v2, s[12:15], s26 offen offset:384 nt
    buffer_load_dwordx4 v[108:111], v2, s[12:15], s26 offen offset:448 nt
    s_waitcnt vmcnt(8)
    v_mfma_f32_16x16x32_bf16 v[120:123], v[16:19], v[48:51], 0
    v_mfma_f32_16x16x32_bf16 v[120:123], v[20:23], v[52:55], v[120:123]
    v_mfma_f32_16x16x32_bf16 v[120:123], v[24:27], v[56:59], v[120:123]
    v_mfma_f32_16x16x32_bf16 v[120:123], v[28:31], v[60:63], v[120:123]
    v_mfma_f32_16x16x32_bf16 v[120:123], v[32:35], v[64:67], v[120:123]
    v_mfma_f32_16x16x32_bf16 v[120:123], v[36:39], v[68:71], v[120:123]
    v_mfma_f32_16x16x32_bf16 v[120:123], v[40:43], v[72:75], v[120:123]
    v_mfma_f32_16x16x32_bf16 v[120:123], v[44:47], v[76:79], v[120:123]
    s_add_u32 s26, s25, 32768
    buffer_load_dwordx4 v[48:51], v2, s[12:15], s26 offen offset:0 nt
    buffer_load_dwordx4 v[52:55], v2, s[12:15], s26 offen offset:64 nt
    buffer_load_dwordx4 v[56:59], v2, s[12:15], s26 offen offset:128 nt
    buffer_load_dwordx4 v[60:63], v2, s[12:15], s26 offen offset:192 nt
    buffer_load_dwordx4 v[64:67], v2, s[12:15], s26 offen offset:256 nt
    buffer_load_dwordx4 v[68:71], v2, s[12:15], s26 offen offset:320 nt
    buffer_load_dwordx4 v[72:75], v2, s[12:15], s26 offen offset:384 nt
    buffer_load_dwordx4 v[76:79], v2, s[12:15], s26 offen offset:448 nt
    s_waitcnt vmcnt(8)
    v_mfma_f32_16x16x32_bf16 v[124:127], v[16:19], v[80:83], 0
    v_mfma_f32_16x16x32_bf16 v[124:127], v[20:23], v[84:87], v[124:127]
    v_mfma_f32_16x16x32_bf16 v[124:127], v[24:27], v[88:91], v[124:127]
    v_mfma_f32_16x16x32_bf16 v[124:127], v[28:31], v[92:95], v[124:127]
    v_mfma_f32_16x16x32_bf16 v[124:127], v[32:35], v[96:99], v[124:127]
    v_mfma_f32_16x16x32_bf16 v[124:127], v[36:39], v[100:103], v[124:127]
    v_mfma_f32_16x16x32_bf16 v[124:127], v[40:43], v[104:107], v[124:127]
    v_mfma_f32_16x16x32_bf16 v[124:127], v[44:47], v[108:111], v[124:127]
    s_add_u32 s26, s25, 40960
    buffer_load_dwordx4 v[80:83], v2, s[12:15], s26 offen offset:0 nt
    buffer_load_dwordx4 v[84:87], v2, s[12:15], s26 offen offset:64 nt
    buffer_load_dwordx4 v[88:91], v2, s[12:15], s26 offen offset:128 nt
    buffer_load_dwordx4 v[92:95], v2, s[12:15], s26 offen offset:192 nt
    buffer_load_dwordx4 v[96:99], v2, s[12:15], s26 offen offset:256 nt
    buffer_load_dwordx4 v[100:103], v2, s[12:15], s26 offen offset:320 nt
    buffer_load_dwordx4 v[104:107], v2, s[12:15], s26 offen offset:384 nt
    buffer_load_dwordx4 v[108:111], v2, s[12:15], s26 offen offset:448 nt
    s_waitcnt vmcnt(8)
    v_mfma_f32_16x16x32_bf16 v[128:131], v[16:19], v[48:51], 0
    v_mfma_f32_16x16x32_bf16 v[128:131], v[20:23], v[52:55], v[128:131]
    v_mfma_f32_16x16x32_bf16 v[128:131], v[24:27], v[56:59], v[128:131]
    v_mfma_f32_16x16x32_bf16 v[128:131], v[28:31], v[60:63], v[128:131]
    v_mfma_f32_16x16x32_bf16 v[128:131], v[32:35], v[64:67], v[128:131]
    v_mfma_f32_16x16x32_bf16 v[128:131], v[36:39], v[68:71], v[128:131]
    v_mfma_f32_16x16x32_bf16 v[128:131], v[40:43], v[72:75], v[128:131]
    v_mfma_f32_16x16x32_bf16 v[128:131], v[44:47], v[76:79], v[128:131]
    s_add_u32 s26, s25, 49152
    buffer_load_dwordx4 v[48:51], v2, s[12:15], s26 offen offset:0 nt
    buffer_load_dwordx4 v[52:55], v2, s[12:15], s26 offen offset:64 nt
    buffer_load_dwordx4 v[56:59], v2, s[12:15], s26 offen offset:128 nt
    buffer_load_dwordx4 v[60:63], v2, s[12:15], s26 offen offset:192 nt
    buffer_load_dwordx4 v[64:67], v2, s[12:15], s26 offen offset:256 nt
    buffer_load_dwordx4 v[68:71], v2, s[12:15], s26 offen offset:320 nt
    buffer_load_dwordx4 v[72:75], v2, s[12:15], s26 offen offset:384 nt
    buffer_load_dwordx4 v[76:79], v2, s[12:15], s26 offen offset:448 nt
    s_waitcnt vmcnt(8)
    v_mfma_f32_16x16x32_bf16 v[132:135], v[16:19], v[80:83], 0
    v_mfma_f32_16x16x32_bf16 v[132:135], v[20:23], v[84:87], v[132:135]
    v_mfma_f32_16x16x32_bf16 v[132:135], v[24:27], v[88:91], v[132:135]
    v_mfma_f32_16x16x32_bf16 v[132:135], v[28:31], v[92:95], v[132:135]
    v_mfma_f32_16x16x32_bf16 v[132:135], v[32:35], v[96:99], v[132:135]
    v_mfma_f32_16x16x32_bf16 v[132:135], v[36:39], v[100:103], v[132:135]
    v_mfma_f32_16x16x32_bf16 v[132:135], v[40:43], v[104:107], v[132:135]
    v_mfma_f32_16x16x32_bf16 v[132:135], v[44:47], v[108:111], v[132:135]
    s_add_u32 s26, s25, 57344
    buffer_load_dwordx4 v[80:83], v2, s[12:15], s26 offen offset:0 nt
    buffer_load_dwordx4 v[84:87], v2, s[12:15], s26 offen offset:64 nt
    buffer_load_dwordx4 v[88:91], v2, s[12:15], s26 offen offset:128 nt
    buffer_load_dwordx4 v[92:95], v2, s[12:15], s26 offen offset:192 nt
    buffer_load_dwordx4 v[96:99], v2, s[12:15], s26 offen offset:256 nt
    buffer_load_dwordx4 v[100:103], v2, s[12:15], s26 offen offset:320 nt
    buffer_load_dwordx4 v[104:107], v2, s[12:15], s26 offen offset:384 nt
    buffer_load_dwordx4 v[108:111], v2, s[12:15], s26 offen offset:448 nt
    s_waitcnt vmcnt(8)
    v_mfma_f32_16x16x32_bf16 v[136:139], v[16:19], v[48:51], 0
    v_mfma_f32_16x16x32_bf16 v[136:139], v[20:23], v[52:55], v[136:139]
    v_mfma_f32_16x16x32_bf16 v[136:139], v[24:27], v[56:59], v[136:139]
    v_mfma_f32_16x16x32_bf16 v[136:139], v[28:31], v[60:63], v[136:139]
    v_mfma_f32_16x16x32_bf16 v[136:139], v[32:35], v[64:67], v[136:139]
    v_mfma_f32_16x16x32_bf16 v[136:139], v[36:39], v[68:71], v[136:139]
    v_mfma_f32_16x16x32_bf16 v[136:139], v[40:43], v[72:75], v[136:139]
    v_mfma_f32_16x16x32_bf16 v[136:139], v[44:47], v[76:79], v[136:139]
    s_mov_b32 s26, s25
    buffer_load_dwordx4 v[48:51], v3, s[16:19], s26 offen offset:0 nt
    buffer_load_dwordx4 v[52:55], v3, s[16:19], s26 offen offset:1024 nt
    buffer_load_dwordx4 v[56:59], v3, s[16:19], s26 offen offset:2048 nt
    buffer_load_dwordx4 v[60:63], v3, s[16:19], s26 offen offset:3072 nt
    s_add_u32 s26, s25, 4096
    buffer_load_dwordx4 v[64:67], v3, s[16:19], s26 offen offset:0 nt
    buffer_load_dwordx4 v[68:71], v3, s[16:19], s26 offen offset:1024 nt
    buffer_load_dwordx4 v[72:75], v3, s[16:19], s26 offen offset:2048 nt
    buffer_load_dwordx4 v[76:79], v3, s[16:19], s26 offen offset:3072 nt
    s_waitcnt vmcnt(8)
    v_mfma_f32_16x16x32_bf16 v[140:143], v[16:19], v[80:83], 0
    v_mfma_f32_16x16x32_bf16 v[140:143], v[20:23], v[84:87], v[140:143]
    v_mfma_f32_16x16x32_bf16 v[140:143], v[24:27], v[88:91], v[140:143]
    v_mfma_f32_16x16x32_bf16 v[140:143], v[28:31], v[92:95], v[140:143]
    v_mfma_f32_16x16x32_bf16 v[140:143], v[32:35], v[96:99], v[140:143]
    v_mfma_f32_16x16x32_bf16 v[140:143], v[36:39], v[100:103], v[140:143]
    v_mfma_f32_16x16x32_bf16 v[140:143], v[40:43], v[104:107], v[140:143]
    v_mfma_f32_16x16x32_bf16 v[140:143], v[44:47], v[108:111], v[140:143]
    s_nop 7
    s_nop 1
    v_cvt_pk_bf16_f32 v112, v112, v112
    v_lshlrev_b32 v112, 16, v112
    v_mul_f32 v112, 0x3db8aa3b, v112
    v_cvt_pk_bf16_f32 v113, v113, v113
    v_lshlrev_b32 v113, 16, v113
    v_mul_f32 v113, 0x3db8aa3b, v113
    v_cvt_pk_bf16_f32 v116, v116, v116
    v_lshlrev_b32 v116, 16, v116
    v_mul_f32 v116, 0x3db8aa3b, v116
    v_cvt_pk_bf16_f32 v117, v117, v117
    v_lshlrev_b32 v117, 16, v117
    v_mul_f32 v117, 0x3db8aa3b, v117
    v_cvt_pk_bf16_f32 v120, v120, v120
    v_lshlrev_b32 v120, 16, v120
    v_mul_f32 v120, 0x3db8aa3b, v120
    v_cvt_pk_bf16_f32 v121, v121, v121
    v_lshlrev_b32 v121, 16, v121
    v_mul_f32 v121, 0x3db8aa3b, v121
    v_cvt_pk_bf16_f32 v124, v124, v124
    v_lshlrev_b32 v124, 16, v124
    v_mul_f32 v124, 0x3db8aa3b, v124
    v_cvt_pk_bf16_f32 v125, v125, v125
    v_lshlrev_b32 v125, 16, v125
    v_mul_f32 v125, 0x3db8aa3b, v125
    v_cvt_pk_bf16_f32 v128, v128, v128
    v_lshlrev_b32 v128, 16, v128
    v_mul_f32 v128, 0x3db8aa3b, v128
    v_cvt_pk_bf16_f32 v129, v129, v129
    v_lshlrev_b32 v129, 16, v129
    v_mul_f32 v129, 0x3db8aa3b, v129
    v_cvt_pk_bf16_f32 v132, v132, v132
    v_lshlrev_b32 v132, 16, v132
    v_mul_f32 v132, 0x3db8aa3b, v132
    v_cvt_pk_bf16_f32 v133, v133, v133
    v_lshlrev_b32 v133, 16, v133
    v_mul_f32 v133, 0x3db8aa3b, v133
    v_cvt_pk_bf16_f32 v136, v136, v136
    v_lshlrev_b32 v136, 16, v136
    v_mul_f32 v136, 0x3db8aa3b, v136
    v_cvt_pk_bf16_f32 v137, v137, v137
    v_lshlrev_b32 v137, 16, v137
    v_mul_f32 v137, 0x3db8aa3b, v137
    v_cvt_pk_bf16_f32 v140, v140, v140
    v_lshlrev_b32 v140, 16, v140
    v_mul_f32 v140, 0x3db8aa3b, v140
    v_cvt_pk_bf16_f32 v141, v141, v141
    v_lshlrev_b32 v141, 16, v141
    v_mul_f32 v141, 0x3db8aa3b, v141
    v_mov_b32 v8, v112
    v_max_f32 v8, v8, v116
    v_max_f32 v8, v8, v120
    v_max_f32 v8, v8, v124
    v_max_f32 v8, v8, v128
    v_max_f32 v8, v8, v132
    v_max_f32 v8, v8, v136
    v_max_f32 v8, v8, v140
    s_nop 1
    v_max_f32_dpp v8, v8, v8 row_shr:1 row_mask:0xf bank_mask:0xf
    s_nop 1
    v_max_f32_dpp v8, v8, v8 row_shr:2 row_mask:0xf bank_mask:0xf
    s_nop 1
    v_max_f32_dpp v8, v8, v8 row_shr:4 row_mask:0xf bank_mask:0xf
    s_nop 1
    v_max_f32_dpp v8, v8, v8 row_shr:8 row_mask:0xf bank_mask:0xf
    s_nop 0
    v_readlane_b32 s32, v8, 15
    v_mov_b32 v9, v113
    v_max_f32 v9, v9, v117
    v_max_f32 v9, v9, v121
    v_max_f32 v9, v9, v125
    v_max_f32 v9, v9, v129
    v_max_f32 v9, v9, v133
    v_max_f32 v9, v9, v137
    v_max_f32 v9, v9, v141
    s_nop 1
    v_max_f32_dpp v9, v9, v9 row_shr:1 row_mask:0xf bank_mask:0xf
    s_nop 1
    v_max_f32_dpp v9, v9, v9 row_shr:2 row_mask:0xf bank_mask:0xf
    s_nop 1
    v_max_f32_dpp v9, v9, v9 row_shr:4 row_mask:0xf bank_mask:0xf
    s_nop 1
    v_max_f32_dpp v9, v9, v9 row_shr:8 row_mask:0xf bank_mask:0xf
    s_nop 0
    v_readlane_b32 s33, v9, 15
    s_nop 1
    v_subrev_f32 v112, s32, v112
    v_exp_f32 v112, v112
    v_subrev_f32 v116, s32, v116
    v_exp_f32 v116, v116
    v_subrev_f32 v120, s32, v120
    v_exp_f32 v120, v120
    v_subrev_f32 v124, s32, v124
    v_exp_f32 v124, v124
    v_subrev_f32 v128, s32, v128
    v_exp_f32 v128, v128
    v_subrev_f32 v132, s32, v132
    v_exp_f32 v132, v132
    v_subrev_f32 v136, s32, v136
    v_exp_f32 v136, v136
    v_subrev_f32 v140, s32, v140
    v_exp_f32 v140, v140
    s_nop 0
    v_mov_b32 v8, v112
    v_add_f32 v8, v8, v116
    v_add_f32 v8, v8, v120
    v_add_f32 v8, v8, v124
    v_add_f32 v8, v8, v128
    v_add_f32 v8, v8, v132
    v_add_f32 v8, v8, v136
    v_add_f32 v8, v8, v140
    s_nop 1
    v_add_f32_dpp v8, v8, v8 row_shr:1 row_mask:0xf bank_mask:0xf bound_ctrl:0
    s_nop 1
    v_add_f32_dpp v8, v8, v8 row_shr:2 row_mask:0xf bank_mask:0xf bound_ctrl:0
    s_nop 1
    v_add_f32_dpp v8, v8, v8 row_shr:4 row_mask:0xf bank_mask:0xf bound_ctrl:0
    s_nop 1
    v_add_f32_dpp v8, v8, v8 row_shr:8 row_mask:0xf bank_mask:0xf bound_ctrl:0
    s_nop 0
    v_readlane_b32 s34, v8, 15
    v_subrev_f32 v113, s33, v113
    v_exp_f32 v113, v113
    v_subrev_f32 v117, s33, v117
    v_exp_f32 v117, v117
    v_subrev_f32 v121, s33, v121
    v_exp_f32 v121, v121
    v_subrev_f32 v125, s33, v125
    v_exp_f32 v125, v125
    v_subrev_f32 v129, s33, v129
    v_exp_f32 v129, v129
    v_subrev_f32 v133, s33, v133
    v_exp_f32 v133, v133
    v_subrev_f32 v137, s33, v137
    v_exp_f32 v137, v137
    v_subrev_f32 v141, s33, v141
    v_exp_f32 v141, v141
    s_nop 0
    v_mov_b32 v9, v113
    v_add_f32 v9, v9, v117
    v_add_f32 v9, v9, v121
    v_add_f32 v9, v9, v125
    v_add_f32 v9, v9, v129
    v_add_f32 v9, v9, v133
    v_add_f32 v9, v9, v137
    v_add_f32 v9, v9, v141
    s_nop 1
    v_add_f32_dpp v9, v9, v9 row_shr:1 row_mask:0xf bank_mask:0xf bound_ctrl:0
    s_nop 1
    v_add_f32_dpp v9, v9, v9 row_shr:2 row_mask:0xf bank_mask:0xf bound_ctrl:0
    s_nop 1
    v_add_f32_dpp v9, v9, v9 row_shr:4 row_mask:0xf bank_mask:0xf bound_ctrl:0
    s_nop 1
    v_add_f32_dpp v9, v9, v9 row_shr:8 row_mask:0xf bank_mask:0xf bound_ctrl:0
    s_nop 0
    v_readlane_b32 s35, v9, 15
    s_mul_i32 s36, s24, 1024
    v_and_b32 v8, 1, v1
    v_mul_u32_u24 v8, 256, v8
    v_lshrrev_b32 v9, 1, v1
    v_lshlrev_b32 v9, 2, v9
    v_add_u32 v8, v8, v9
    v_add_u32 v8, s36, v8
    v_cmp_gt_u32 vcc, 16, v1
    s_and_saveexec_b64 s[30:31], vcc
    ds_write_b32 v8, v112 offset:0
    ds_write_b32 v8, v116 offset:32
    ds_write_b32 v8, v120 offset:64
    ds_write_b32 v8, v124 offset:96
    ds_write_b32 v8, v128 offset:128
    ds_write_b32 v8, v132 offset:160
    ds_write_b32 v8, v136 offset:192
    ds_write_b32 v8, v140 offset:224
    ds_write_b32 v8, v113 offset:512
    ds_write_b32 v8, v117 offset:544
    ds_write_b32 v8, v121 offset:576
    ds_write_b32 v8, v125 offset:608
    ds_write_b32 v8, v129 offset:640
    ds_write_b32 v8, v133 offset:672
    ds_write_b32 v8, v137 offset:704
    ds_write_b32 v8, v141 offset:736
    s_mov_b64 exec, s[30:31]
    v_lshrrev_b32 v9, 5, v1
    v_mul_u32_u24 v9, 256, v9
    v_add_u32 v9, s36, v9
    v_mov_b32 v144, 0
    v_mov_b32 v145, 0
    v_mov_b32 v146, 0
    v_mov_b32 v147, 0
    v_mov_b32 v148, 0
    v_mov_b32 v149, 0
    v_mov_b32 v150, 0
    v_mov_b32 v151, 0
    v_mov_b32 v152, 0
    v_mov_b32 v153, 0
    v_mov_b32 v154, 0
    v_mov_b32 v155, 0
    v_mov_b32 v156, 0
    v_mov_b32 v157, 0
    v_mov_b32 v158, 0
    v_mov_b32 v159, 0
    s_waitcnt lgkmcnt(0)
    ds_read_b128 v[160:163], v9 offset:0
    ds_read_b128 v[164:167], v9 offset:16
    ds_read_b128 v[168:171], v9 offset:512
    ds_read_b128 v[172:175], v9 offset:528
    s_add_u32 s26, s25, 8192
    buffer_load_dwordx4 v[80:83], v3, s[16:19], s26 offen offset:0 nt
    buffer_load_dwordx4 v[84:87], v3, s[16:19], s26 offen offset:1024 nt
    buffer_load_dwordx4 v[88:91], v3, s[16:19], s26 offen offset:2048 nt
    buffer_load_dwordx4 v[92:95], v3, s[16:19], s26 offen offset:3072 nt
    s_add_u32 s26, s25, 12288
    buffer_load_dwordx4 v[96:99], v3, s[16:19], s26 offen offset:0 nt
    buffer_load_dwordx4 v[100:103], v3, s[16:19], s26 offen offset:1024 nt
    buffer_load_dwordx4 v[104:107], v3, s[16:19], s26 offen offset:2048 nt
    buffer_load_dwordx4 v[108:111], v3, s[16:19], s26 offen offset:3072 nt
    s_waitcnt vmcnt(8) lgkmcnt(0)
    v_lshlrev_b32 v10, 16, v48
    v_and_b32 v11, 0xffff0000, v48
    v_fmac_f32 v144, v160, v10
    v_fmac_f32 v145, v160, v11
    v_fmac_f32 v152, v168, v10
    v_fmac_f32 v153, v168, v11
    v_lshlrev_b32 v10, 16, v49
    v_and_b32 v11, 0xffff0000, v49
    v_fmac_f32 v146, v160, v10
    v_fmac_f32 v147, v160, v11
    v_fmac_f32 v154, v168, v10
    v_fmac_f32 v155, v168, v11
    v_lshlrev_b32 v10, 16, v50
    v_and_b32 v11, 0xffff0000, v50
    v_fmac_f32 v148, v160, v10
    v_fmac_f32 v149, v160, v11
    v_fmac_f32 v156, v168, v10
    v_fmac_f32 v157, v168, v11
    v_lshlrev_b32 v10, 16, v51
    v_and_b32 v11, 0xffff0000, v51
    v_fmac_f32 v150, v160, v10
    v_fmac_f32 v151, v160, v11
    v_fmac_f32 v158, v168, v10
    v_fmac_f32 v159, v168, v11
    v_lshlrev_b32 v10, 16, v52
    v_and_b32 v11, 0xffff0000, v52
    v_fmac_f32 v144, v161, v10
    v_fmac_f32 v145, v161, v11
    v_fmac_f32 v152, v169, v10
    v_fmac_f32 v153, v169, v11
    v_lshlrev_b32 v10, 16, v53
    v_and_b32 v11, 0xffff0000, v53
    v_fmac_f32 v146, v161, v10
    v_fmac_f32 v147, v161, v11
    v_fmac_f32 v154, v169, v10
    v_fmac_f32 v155, v169, v11
    v_lshlrev_b32 v10, 16, v54
    v_and_b32 v11, 0xffff0000, v54
    v_fmac_f32 v148, v161, v10
    v_fmac_f32 v149, v161, v11
    v_fmac_f32 v156, v169, v10
    v_fmac_f32 v157, v169, v11
    v_lshlrev_b32 v10, 16, v55
    v_and_b32 v11, 0xffff0000, v55
    v_fmac_f32 v150, v161, v10
    v_fmac_f32 v151, v161, v11
    v_fmac_f32 v158, v169, v10
    v_fmac_f32 v159, v169, v11
    v_lshlrev_b32 v10, 16, v56
    v_and_b32 v11, 0xffff0000, v56
    v_fmac_f32 v144, v162, v10
    v_fmac_f32 v145, v162, v11
    v_fmac_f32 v152, v170, v10
    v_fmac_f32 v153, v170, v11
    v_lshlrev_b32 v10, 16, v57
    v_and_b32 v11, 0xffff0000, v57
    v_fmac_f32 v146, v162, v10
    v_fmac_f32 v147, v162, v11
    v_fmac_f32 v154, v170, v10
    v_fmac_f32 v155, v170, v11
    v_lshlrev_b32 v10, 16, v58
    v_and_b32 v11, 0xffff0000, v58
    v_fmac_f32 v148, v162, v10
    v_fmac_f32 v149, v162, v11
    v_fmac_f32 v156, v170, v10
    v_fmac_f32 v157, v170, v11
    v_lshlrev_b32 v10, 16, v59
    v_and_b32 v11, 0xffff0000, v59
    v_fmac_f32 v150, v162, v10
    v_fmac_f32 v151, v162, v11
    v_fmac_f32 v158, v170, v10
    v_fmac_f32 v159, v170, v11
    v_lshlrev_b32 v10, 16, v60
    v_and_b32 v11, 0xffff0000, v60
    v_fmac_f32 v144, v163, v10
    v_fmac_f32 v145, v163, v11
    v_fmac_f32 v152, v171, v10
    v_fmac_f32 v153, v171, v11
    v_lshlrev_b32 v10, 16, v61
    v_and_b32 v11, 0xffff0000, v61
    v_fmac_f32 v146, v163, v10
    v_fmac_f32 v147, v163, v11
    v_fmac_f32 v154, v171, v10
    v_fmac_f32 v155, v171, v11
    v_lshlrev_b32 v10, 16, v62
    v_and_b32 v11, 0xffff0000, v62
    v_fmac_f32 v148, v163, v10
    v_fmac_f32 v149, v163, v11
    v_fmac_f32 v156, v171, v10
    v_fmac_f32 v157, v171, v11
    v_lshlrev_b32 v10, 16, v63
    v_and_b32 v11, 0xffff0000, v63
    v_fmac_f32 v150, v163, v10
    v_fmac_f32 v151, v163, v11
    v_fmac_f32 v158, v171, v10
    v_fmac_f32 v159, v171, v11
    v_lshlrev_b32 v10, 16, v64
    v_and_b32 v11, 0xffff0000, v64
    v_fmac_f32 v144, v164, v10
    v_fmac_f32 v145, v164, v11
    v_fmac_f32 v152, v172, v10
    v_fmac_f32 v153, v172, v11
    v_lshlrev_b32 v10, 16, v65
    v_and_b32 v11, 0xffff0000, v65
    v_fmac_f32 v146, v164, v10
    v_fmac_f32 v147, v164, v11
    v_fmac_f32 v154, v172, v10
    v_fmac_f32 v155, v172, v11
    v_lshlrev_b32 v10, 16, v66
    v_and_b32 v11, 0xffff0000, v66
    v_fmac_f32 v148, v164, v10
    v_fmac_f32 v149, v164, v11
    v_fmac_f32 v156, v172, v10
    v_fmac_f32 v157, v172, v11
    v_lshlrev_b32 v10, 16, v67
    v_and_b32 v11, 0xffff0000, v67
    v_fmac_f32 v150, v164, v10
    v_fmac_f32 v151, v164, v11
    v_fmac_f32 v158, v172, v10
    v_fmac_f32 v159, v172, v11
    v_lshlrev_b32 v10, 16, v68
    v_and_b32 v11, 0xffff0000, v68
    v_fmac_f32 v144, v165, v10
    v_fmac_f32 v145, v165, v11
    v_fmac_f32 v152, v173, v10
    v_fmac_f32 v153, v173, v11
    v_lshlrev_b32 v10, 16, v69
    v_and_b32 v11, 0xffff0000, v69
    v_fmac_f32 v146, v165, v10
    v_fmac_f32 v147, v165, v11
    v_fmac_f32 v154, v173, v10
    v_fmac_f32 v155, v173, v11
    v_lshlrev_b32 v10, 16, v70
    v_and_b32 v11, 0xffff0000, v70
    v_fmac_f32 v148, v165, v10
    v_fmac_f32 v149, v165, v11
    v_fmac_f32 v156, v173, v10
    v_fmac_f32 v157, v173, v11
    v_lshlrev_b32 v10, 16, v71
    v_and_b32 v11, 0xffff0000, v71
    v_fmac_f32 v150, v165, v10
    v_fmac_f32 v151, v165, v11
    v_fmac_f32 v158, v173, v10
    v_fmac_f32 v159, v173, v11
    v_lshlrev_b32 v10, 16, v72
    v_and_b32 v11, 0xffff0000, v72
    v_fmac_f32 v144, v166, v10
    v_fmac_f32 v145, v166, v11
    v_fmac_f32 v152, v174, v10
    v_fmac_f32 v153, v174, v11
    v_lshlrev_b32 v10, 16, v73
    v_and_b32 v11, 0xffff0000, v73
    v_fmac_f32 v146, v166, v10
    v_fmac_f32 v147, v166, v11
    v_fmac_f32 v154, v174, v10
    v_fmac_f32 v155, v174, v11
    v_lshlrev_b32 v10, 16, v74
    v_and_b32 v11, 0xffff0000, v74
    v_fmac_f32 v148, v166, v10
    v_fmac_f32 v149, v166, v11
    v_fmac_f32 v156, v174, v10
    v_fmac_f32 v157, v174, v11
    v_lshlrev_b32 v10, 16, v75
    v_and_b32 v11, 0xffff0000, v75
    v_fmac_f32 v150, v166, v10
    v_fmac_f32 v151, v166, v11
    v_fmac_f32 v158, v174, v10
    v_fmac_f32 v159, v174, v11
    v_lshlrev_b32 v10, 16, v76
    v_and_b32 v11, 0xffff0000, v76
    v_fmac_f32 v144, v167, v10
    v_fmac_f32 v145, v167, v11
    v_fmac_f32 v152, v175, v10
    v_fmac_f32 v153, v175, v11
    v_lshlrev_b32 v10, 16, v77
    v_and_b32 v11, 0xffff0000, v77
    v_fmac_f32 v146, v167, v10
    v_fmac_f32 v147, v167, v11
    v_fmac_f32 v154, v175, v10
    v_fmac_f32 v155, v175, v11
    v_lshlrev_b32 v10, 16, v78
    v_and_b32 v11, 0xffff0000, v78
    v_fmac_f32 v148, v167, v10
    v_fmac_f32 v149, v167, v11
    v_fmac_f32 v156, v175, v10
    v_fmac_f32 v157, v175, v11
    v_lshlrev_b32 v10, 16, v79
    v_and_b32 v11, 0xffff0000, v79
    v_fmac_f32 v150, v167, v10
    v_fmac_f32 v151, v167, v11
    v_fmac_f32 v158, v175, v10
    v_fmac_f32 v159, v175, v11
    ds_read_b128 v[160:163], v9 offset:32
    ds_read_b128 v[164:167], v9 offset:48
    ds_read_b128 v[168:171], v9 offset:544
    ds_read_b128 v[172:175], v9 offset:560
    s_add_u32 s26, s25, 16384
    buffer_load_dwordx4 v[48:51], v3, s[16:19], s26 offen offset:0 nt
    buffer_load_dwordx4 v[52:55], v3, s[16:19], s26 offen offset:1024 nt
    buffer_load_dwordx4 v[56:59], v3, s[16:19], s26 offen offset:2048 nt
    buffer_load_dwordx4 v[60:63], v3, s[16:19], s26 offen offset:3072 nt
    s_add_u32 s26, s25, 20480
    buffer_load_dwordx4 v[64:67], v3, s[16:19], s26 offen offset:0 nt
    buffer_load_dwordx4 v[68:71], v3, s[16:19], s26 offen offset:1024 nt
    buffer_load_dwordx4 v[72:75], v3, s[16:19], s26 offen offset:2048 nt
    buffer_load_dwordx4 v[76:79], v3, s[16:19], s26 offen offset:3072 nt
    s_waitcnt vmcnt(8) lgkmcnt(0)
    v_lshlrev_b32 v10, 16, v80
    v_and_b32 v11, 0xffff0000, v80
    v_fmac_f32 v144, v160, v10
    v_fmac_f32 v145, v160, v11
    v_fmac_f32 v152, v168, v10
    v_fmac_f32 v153, v168, v11
    v_lshlrev_b32 v10, 16, v81
    v_and_b32 v11, 0xffff0000, v81
    v_fmac_f32 v146, v160, v10
    v_fmac_f32 v147, v160, v11
    v_fmac_f32 v154, v168, v10
    v_fmac_f32 v155, v168, v11
    v_lshlrev_b32 v10, 16, v82
    v_and_b32 v11, 0xffff0000, v82
    v_fmac_f32 v148, v160, v10
    v_fmac_f32 v149, v160, v11
    v_fmac_f32 v156, v168, v10
    v_fmac_f32 v157, v168, v11
    v_lshlrev_b32 v10, 16, v83
    v_and_b32 v11, 0xffff0000, v83
    v_fmac_f32 v150, v160, v10
    v_fmac_f32 v151, v160, v11
    v_fmac_f32 v158, v168, v10
    v_fmac_f32 v159, v168, v11
    v_lshlrev_b32 v10, 16, v84
    v_and_b32 v11, 0xffff0000, v84
    v_fmac_f32 v144, v161, v10
    v_fmac_f32 v145, v161, v11
    v_fmac_f32 v152, v169, v10
    v_fmac_f32 v153, v169, v11
    v_lshlrev_b32 v10, 16, v85
    v_and_b32 v11, 0xffff0000, v85
    v_fmac_f32 v146, v161, v10
    v_fmac_f32 v147, v161, v11
    v_fmac_f32 v154, v169, v10
    v_fmac_f32 v155, v169, v11
    v_lshlrev_b32 v10, 16, v86
    v_and_b32 v11, 0xffff0000, v86
    v_fmac_f32 v148, v161, v10
    v_fmac_f32 v149, v161, v11
    v_fmac_f32 v156, v169, v10
    v_fmac_f32 v157, v169, v11
    v_lshlrev_b32 v10, 16, v87
    v_and_b32 v11, 0xffff0000, v87
    v_fmac_f32 v150, v161, v10
    v_fmac_f32 v151, v161, v11
    v_fmac_f32 v158, v169, v10
    v_fmac_f32 v159, v169, v11
    v_lshlrev_b32 v10, 16, v88
    v_and_b32 v11, 0xffff0000, v88
    v_fmac_f32 v144, v162, v10
    v_fmac_f32 v145, v162, v11
    v_fmac_f32 v152, v170, v10
    v_fmac_f32 v153, v170, v11
    v_lshlrev_b32 v10, 16, v89
    v_and_b32 v11, 0xffff0000, v89
    v_fmac_f32 v146, v162, v10
    v_fmac_f32 v147, v162, v11
    v_fmac_f32 v154, v170, v10
    v_fmac_f32 v155, v170, v11
    v_lshlrev_b32 v10, 16, v90
    v_and_b32 v11, 0xffff0000, v90
    v_fmac_f32 v148, v162, v10
    v_fmac_f32 v149, v162, v11
    v_fmac_f32 v156, v170, v10
    v_fmac_f32 v157, v170, v11
    v_lshlrev_b32 v10, 16, v91
    v_and_b32 v11, 0xffff0000, v91
    v_fmac_f32 v150, v162, v10
    v_fmac_f32 v151, v162, v11
    v_fmac_f32 v158, v170, v10
    v_fmac_f32 v159, v170, v11
    v_lshlrev_b32 v10, 16, v92
    v_and_b32 v11, 0xffff0000, v92
    v_fmac_f32 v144, v163, v10
    v_fmac_f32 v145, v163, v11
    v_fmac_f32 v152, v171, v10
    v_fmac_f32 v153, v171, v11
    v_lshlrev_b32 v10, 16, v93
    v_and_b32 v11, 0xffff0000, v93
    v_fmac_f32 v146, v163, v10
    v_fmac_f32 v147, v163, v11
    v_fmac_f32 v154, v171, v10
    v_fmac_f32 v155, v171, v11
    v_lshlrev_b32 v10, 16, v94
    v_and_b32 v11, 0xffff0000, v94
    v_fmac_f32 v148, v163, v10
    v_fmac_f32 v149, v163, v11
    v_fmac_f32 v156, v171, v10
    v_fmac_f32 v157, v171, v11
    v_lshlrev_b32 v10, 16, v95
    v_and_b32 v11, 0xffff0000, v95
    v_fmac_f32 v150, v163, v10
    v_fmac_f32 v151, v163, v11
    v_fmac_f32 v158, v171, v10
    v_fmac_f32 v159, v171, v11
    v_lshlrev_b32 v10, 16, v96
    v_and_b32 v11, 0xffff0000, v96
    v_fmac_f32 v144, v164, v10
    v_fmac_f32 v145, v164, v11
    v_fmac_f32 v152, v172, v10
    v_fmac_f32 v153, v172, v11
    v_lshlrev_b32 v10, 16, v97
    v_and_b32 v11, 0xffff0000, v97
    v_fmac_f32 v146, v164, v10
    v_fmac_f32 v147, v164, v11
    v_fmac_f32 v154, v172, v10
    v_fmac_f32 v155, v172, v11
    v_lshlrev_b32 v10, 16, v98
    v_and_b32 v11, 0xffff0000, v98
    v_fmac_f32 v148, v164, v10
    v_fmac_f32 v149, v164, v11
    v_fmac_f32 v156, v172, v10
    v_fmac_f32 v157, v172, v11
    v_lshlrev_b32 v10, 16, v99
    v_and_b32 v11, 0xffff0000, v99
    v_fmac_f32 v150, v164, v10
    v_fmac_f32 v151, v164, v11
    v_fmac_f32 v158, v172, v10
    v_fmac_f32 v159, v172, v11
    v_lshlrev_b32 v10, 16, v100
    v_and_b32 v11, 0xffff0000, v100
    v_fmac_f32 v144, v165, v10
    v_fmac_f32 v145, v165, v11
    v_fmac_f32 v152, v173, v10
    v_fmac_f32 v153, v173, v11
    v_lshlrev_b32 v10, 16, v101
    v_and_b32 v11, 0xffff0000, v101
    v_fmac_f32 v146, v165, v10
    v_fmac_f32 v147, v165, v11
    v_fmac_f32 v154, v173, v10
    v_fmac_f32 v155, v173, v11
    v_lshlrev_b32 v10, 16, v102
    v_and_b32 v11, 0xffff0000, v102
    v_fmac_f32 v148, v165, v10
    v_fmac_f32 v149, v165, v11
    v_fmac_f32 v156, v173, v10
    v_fmac_f32 v157, v173, v11
    v_lshlrev_b32 v10, 16, v103
    v_and_b32 v11, 0xffff0000, v103
    v_fmac_f32 v150, v165, v10
    v_fmac_f32 v151, v165, v11
    v_fmac_f32 v158, v173, v10
    v_fmac_f32 v159, v173, v11
    v_lshlrev_b32 v10, 16, v104
    v_and_b32 v11, 0xffff0000, v104
    v_fmac_f32 v144, v166, v10
    v_fmac_f32 v145, v166, v11
    v_fmac_f32 v152, v174, v10
    v_fmac_f32 v153, v174, v11
    v_lshlrev_b32 v10, 16, v105
    v_and_b32 v11, 0xffff0000, v105
    v_fmac_f32 v146, v166, v10
    v_fmac_f32 v147, v166, v11
    v_fmac_f32 v154, v174, v10
    v_fmac_f32 v155, v174, v11
    v_lshlrev_b32 v10, 16, v106
    v_and_b32 v11, 0xffff0000, v106
    v_fmac_f32 v148, v166, v10
    v_fmac_f32 v149, v166, v11
    v_fmac_f32 v156, v174, v10
    v_fmac_f32 v157, v174, v11
    v_lshlrev_b32 v10, 16, v107
    v_and_b32 v11, 0xffff0000, v107
    v_fmac_f32 v150, v166, v10
    v_fmac_f32 v151, v166, v11
    v_fmac_f32 v158, v174, v10
    v_fmac_f32 v159, v174, v11
    v_lshlrev_b32 v10, 16, v108
    v_and_b32 v11, 0xffff0000, v108
    v_fmac_f32 v144, v167, v10
    v_fmac_f32 v145, v167, v11
    v_fmac_f32 v152, v175, v10
    v_fmac_f32 v153, v175, v11
    v_lshlrev_b32 v10, 16, v109
    v_and_b32 v11, 0xffff0000, v109
    v_fmac_f32 v146, v167, v10
    v_fmac_f32 v147, v167, v11
    v_fmac_f32 v154, v175, v10
    v_fmac_f32 v155, v175, v11
    v_lshlrev_b32 v10, 16, v110
    v_and_b32 v11, 0xffff0000, v110
    v_fmac_f32 v148, v167, v10
    v_fmac_f32 v149, v167, v11
    v_fmac_f32 v156, v175, v10
    v_fmac_f32 v157, v175, v11
    v_lshlrev_b32 v10, 16, v111
    v_and_b32 v11, 0xffff0000, v111
    v_fmac_f32 v150, v167, v10
    v_fmac_f32 v151, v167, v11
    v_fmac_f32 v158, v175, v10
    v_fmac_f32 v159, v175, v11
    ds_read_b128 v[160:163], v9 offset:64
    ds_read_b128 v[164:167], v9 offset:80
    ds_read_b128 v[168:171], v9 offset:576
    ds_read_b128 v[172:175], v9 offset:592
    s_add_u32 s26, s25, 24576
    buffer_load_dwordx4 v[80:83], v3, s[16:19], s26 offen offset:0 nt
    buffer_load_dwordx4 v[84:87], v3, s[16:19], s26 offen offset:1024 nt
    buffer_load_dwordx4 v[88:91], v3, s[16:19], s26 offen offset:2048 nt
    buffer_load_dwordx4 v[92:95], v3, s[16:19], s26 offen offset:3072 nt
    s_add_u32 s26, s25, 28672
    buffer_load_dwordx4 v[96:99], v3, s[16:19], s26 offen offset:0 nt
    buffer_load_dwordx4 v[100:103], v3, s[16:19], s26 offen offset:1024 nt
    buffer_load_dwordx4 v[104:107], v3, s[16:19], s26 offen offset:2048 nt
    buffer_load_dwordx4 v[108:111], v3, s[16:19], s26 offen offset:3072 nt
    s_waitcnt vmcnt(8) lgkmcnt(0)
    v_lshlrev_b32 v10, 16, v48
    v_and_b32 v11, 0xffff0000, v48
    v_fmac_f32 v144, v160, v10
    v_fmac_f32 v145, v160, v11
    v_fmac_f32 v152, v168, v10
    v_fmac_f32 v153, v168, v11
    v_lshlrev_b32 v10, 16, v49
    v_and_b32 v11, 0xffff0000, v49
    v_fmac_f32 v146, v160, v10
    v_fmac_f32 v147, v160, v11
    v_fmac_f32 v154, v168, v10
    v_fmac_f32 v155, v168, v11
    v_lshlrev_b32 v10, 16, v50
    v_and_b32 v11, 0xffff0000, v50
    v_fmac_f32 v148, v160, v10
    v_fmac_f32 v149, v160, v11
    v_fmac_f32 v156, v168, v10
    v_fmac_f32 v157, v168, v11
    v_lshlrev_b32 v10, 16, v51
    v_and_b32 v11, 0xffff0000, v51
    v_fmac_f32 v150, v160, v10
    v_fmac_f32 v151, v160, v11
    v_fmac_f32 v158, v168, v10
    v_fmac_f32 v159, v168, v11
    v_lshlrev_b32 v10, 16, v52
    v_and_b32 v11, 0xffff0000, v52
    v_fmac_f32 v144, v161, v10
    v_fmac_f32 v145, v161, v11
    v_fmac_f32 v152, v169, v10
    v_fmac_f32 v153, v169, v11
    v_lshlrev_b32 v10, 16, v53
    v_and_b32 v11, 0xffff0000, v53
    v_fmac_f32 v146, v161, v10
    v_fmac_f32 v147, v161, v11
    v_fmac_f32 v154, v169, v10
    v_fmac_f32 v155, v169, v11
    v_lshlrev_b32 v10, 16, v54
    v_and_b32 v11, 0xffff0000, v54
    v_fmac_f32 v148, v161, v10
    v_fmac_f32 v149, v161, v11
    v_fmac_f32 v156, v169, v10
    v_fmac_f32 v157, v169, v11
    v_lshlrev_b32 v10, 16, v55
    v_and_b32 v11, 0xffff0000, v55
    v_fmac_f32 v150, v161, v10
    v_fmac_f32 v151, v161, v11
    v_fmac_f32 v158, v169, v10
    v_fmac_f32 v159, v169, v11
    v_lshlrev_b32 v10, 16, v56
    v_and_b32 v11, 0xffff0000, v56
    v_fmac_f32 v144, v162, v10
    v_fmac_f32 v145, v162, v11
    v_fmac_f32 v152, v170, v10
    v_fmac_f32 v153, v170, v11
    v_lshlrev_b32 v10, 16, v57
    v_and_b32 v11, 0xffff0000, v57
    v_fmac_f32 v146, v162, v10
    v_fmac_f32 v147, v162, v11
    v_fmac_f32 v154, v170, v10
    v_fmac_f32 v155, v170, v11
    v_lshlrev_b32 v10, 16, v58
    v_and_b32 v11, 0xffff0000, v58
    v_fmac_f32 v148, v162, v10
    v_fmac_f32 v149, v162, v11
    v_fmac_f32 v156, v170, v10
    v_fmac_f32 v157, v170, v11
    v_lshlrev_b32 v10, 16, v59
    v_and_b32 v11, 0xffff0000, v59
    v_fmac_f32 v150, v162, v10
    v_fmac_f32 v151, v162, v11
    v_fmac_f32 v158, v170, v10
    v_fmac_f32 v159, v170, v11
    v_lshlrev_b32 v10, 16, v60
    v_and_b32 v11, 0xffff0000, v60
    v_fmac_f32 v144, v163, v10
    v_fmac_f32 v145, v163, v11
    v_fmac_f32 v152, v171, v10
    v_fmac_f32 v153, v171, v11
    v_lshlrev_b32 v10, 16, v61
    v_and_b32 v11, 0xffff0000, v61
    v_fmac_f32 v146, v163, v10
    v_fmac_f32 v147, v163, v11
    v_fmac_f32 v154, v171, v10
    v_fmac_f32 v155, v171, v11
    v_lshlrev_b32 v10, 16, v62
    v_and_b32 v11, 0xffff0000, v62
    v_fmac_f32 v148, v163, v10
    v_fmac_f32 v149, v163, v11
    v_fmac_f32 v156, v171, v10
    v_fmac_f32 v157, v171, v11
    v_lshlrev_b32 v10, 16, v63
    v_and_b32 v11, 0xffff0000, v63
    v_fmac_f32 v150, v163, v10
    v_fmac_f32 v151, v163, v11
    v_fmac_f32 v158, v171, v10
    v_fmac_f32 v159, v171, v11
    v_lshlrev_b32 v10, 16, v64
    v_and_b32 v11, 0xffff0000, v64
    v_fmac_f32 v144, v164, v10
    v_fmac_f32 v145, v164, v11
    v_fmac_f32 v152, v172, v10
    v_fmac_f32 v153, v172, v11
    v_lshlrev_b32 v10, 16, v65
    v_and_b32 v11, 0xffff0000, v65
    v_fmac_f32 v146, v164, v10
    v_fmac_f32 v147, v164, v11
    v_fmac_f32 v154, v172, v10
    v_fmac_f32 v155, v172, v11
    v_lshlrev_b32 v10, 16, v66
    v_and_b32 v11, 0xffff0000, v66
    v_fmac_f32 v148, v164, v10
    v_fmac_f32 v149, v164, v11
    v_fmac_f32 v156, v172, v10
    v_fmac_f32 v157, v172, v11
    v_lshlrev_b32 v10, 16, v67
    v_and_b32 v11, 0xffff0000, v67
    v_fmac_f32 v150, v164, v10
    v_fmac_f32 v151, v164, v11
    v_fmac_f32 v158, v172, v10
    v_fmac_f32 v159, v172, v11
    v_lshlrev_b32 v10, 16, v68
    v_and_b32 v11, 0xffff0000, v68
    v_fmac_f32 v144, v165, v10
    v_fmac_f32 v145, v165, v11
    v_fmac_f32 v152, v173, v10
    v_fmac_f32 v153, v173, v11
    v_lshlrev_b32 v10, 16, v69
    v_and_b32 v11, 0xffff0000, v69
    v_fmac_f32 v146, v165, v10
    v_fmac_f32 v147, v165, v11
    v_fmac_f32 v154, v173, v10
    v_fmac_f32 v155, v173, v11
    v_lshlrev_b32 v10, 16, v70
    v_and_b32 v11, 0xffff0000, v70
    v_fmac_f32 v148, v165, v10
    v_fmac_f32 v149, v165, v11
    v_fmac_f32 v156, v173, v10
    v_fmac_f32 v157, v173, v11
    v_lshlrev_b32 v10, 16, v71
    v_and_b32 v11, 0xffff0000, v71
    v_fmac_f32 v150, v165, v10
    v_fmac_f32 v151, v165, v11
    v_fmac_f32 v158, v173, v10
    v_fmac_f32 v159, v173, v11
    v_lshlrev_b32 v10, 16, v72
    v_and_b32 v11, 0xffff0000, v72
    v_fmac_f32 v144, v166, v10
    v_fmac_f32 v145, v166, v11
    v_fmac_f32 v152, v174, v10
    v_fmac_f32 v153, v174, v11
    v_lshlrev_b32 v10, 16, v73
    v_and_b32 v11, 0xffff0000, v73
    v_fmac_f32 v146, v166, v10
    v_fmac_f32 v147, v166, v11
    v_fmac_f32 v154, v174, v10
    v_fmac_f32 v155, v174, v11
    v_lshlrev_b32 v10, 16, v74
    v_and_b32 v11, 0xffff0000, v74
    v_fmac_f32 v148, v166, v10
    v_fmac_f32 v149, v166, v11
    v_fmac_f32 v156, v174, v10
    v_fmac_f32 v157, v174, v11
    v_lshlrev_b32 v10, 16, v75
    v_and_b32 v11, 0xffff0000, v75
    v_fmac_f32 v150, v166, v10
    v_fmac_f32 v151, v166, v11
    v_fmac_f32 v158, v174, v10
    v_fmac_f32 v159, v174, v11
    v_lshlrev_b32 v10, 16, v76
    v_and_b32 v11, 0xffff0000, v76
    v_fmac_f32 v144, v167, v10
    v_fmac_f32 v145, v167, v11
    v_fmac_f32 v152, v175, v10
    v_fmac_f32 v153, v175, v11
    v_lshlrev_b32 v10, 16, v77
    v_and_b32 v11, 0xffff0000, v77
    v_fmac_f32 v146, v167, v10
    v_fmac_f32 v147, v167, v11
    v_fmac_f32 v154, v175, v10
    v_fmac_f32 v155, v175, v11
    v_lshlrev_b32 v10, 16, v78
    v_and_b32 v11, 0xffff0000, v78
    v_fmac_f32 v148, v167, v10
    v_fmac_f32 v149, v167, v11
    v_fmac_f32 v156, v175, v10
    v_fmac_f32 v157, v175, v11
    v_lshlrev_b32 v10, 16, v79
    v_and_b32 v11, 0xffff0000, v79
    v_fmac_f32 v150, v167, v10
    v_fmac_f32 v151, v167, v11
    v_fmac_f32 v158, v175, v10
    v_fmac_f32 v159, v175, v11
    ds_read_b128 v[160:163], v9 offset:96
    ds_read_b128 v[164:167], v9 offset:112
    ds_read_b128 v[168:171], v9 offset:608
    ds_read_b128 v[172:175], v9 offset:624
    s_add_u32 s26, s25, 32768
    buffer_load_dwordx4 v[48:51], v3, s[16:19], s26 offen offset:0 nt
    buffer_load_dwordx4 v[52:55], v3, s[16:19], s26 offen offset:1024 nt
    buffer_load_dwordx4 v[56:59], v3, s[16:19], s26 offen offset:2048 nt
    buffer_load_dwordx4 v[60:63], v3, s[16:19], s26 offen offset:3072 nt
    s_add_u32 s26, s25, 36864
    buffer_load_dwordx4 v[64:67], v3, s[16:19], s26 offen offset:0 nt
    buffer_load_dwordx4 v[68:71], v3, s[16:19], s26 offen offset:1024 nt
    buffer_load_dwordx4 v[72:75], v3, s[16:19], s26 offen offset:2048 nt
    buffer_load_dwordx4 v[76:79], v3, s[16:19], s26 offen offset:3072 nt
    s_waitcnt vmcnt(8) lgkmcnt(0)
    v_lshlrev_b32 v10, 16, v80
    v_and_b32 v11, 0xffff0000, v80
    v_fmac_f32 v144, v160, v10
    v_fmac_f32 v145, v160, v11
    v_fmac_f32 v152, v168, v10
    v_fmac_f32 v153, v168, v11
    v_lshlrev_b32 v10, 16, v81
    v_and_b32 v11, 0xffff0000, v81
    v_fmac_f32 v146, v160, v10
    v_fmac_f32 v147, v160, v11
    v_fmac_f32 v154, v168, v10
    v_fmac_f32 v155, v168, v11
    v_lshlrev_b32 v10, 16, v82
    v_and_b32 v11, 0xffff0000, v82
    v_fmac_f32 v148, v160, v10
    v_fmac_f32 v149, v160, v11
    v_fmac_f32 v156, v168, v10
    v_fmac_f32 v157, v168, v11
    v_lshlrev_b32 v10, 16, v83
    v_and_b32 v11, 0xffff0000, v83
    v_fmac_f32 v150, v160, v10
    v_fmac_f32 v151, v160, v11
    v_fmac_f32 v158, v168, v10
    v_fmac_f32 v159, v168, v11
    v_lshlrev_b32 v10, 16, v84
    v_and_b32 v11, 0xffff0000, v84
    v_fmac_f32 v144, v161, v10
    v_fmac_f32 v145, v161, v11
    v_fmac_f32 v152, v169, v10
    v_fmac_f32 v153, v169, v11
    v_lshlrev_b32 v10, 16, v85
    v_and_b32 v11, 0xffff0000, v85
    v_fmac_f32 v146, v161, v10
    v_fmac_f32 v147, v161, v11
    v_fmac_f32 v154, v169, v10
    v_fmac_f32 v155, v169, v11
    v_lshlrev_b32 v10, 16, v86
    v_and_b32 v11, 0xffff0000, v86
    v_fmac_f32 v148, v161, v10
    v_fmac_f32 v149, v161, v11
    v_fmac_f32 v156, v169, v10
    v_fmac_f32 v157, v169, v11
    v_lshlrev_b32 v10, 16, v87
    v_and_b32 v11, 0xffff0000, v87
    v_fmac_f32 v150, v161, v10
    v_fmac_f32 v151, v161, v11
    v_fmac_f32 v158, v169, v10
    v_fmac_f32 v159, v169, v11
    v_lshlrev_b32 v10, 16, v88
    v_and_b32 v11, 0xffff0000, v88
    v_fmac_f32 v144, v162, v10
    v_fmac_f32 v145, v162, v11
    v_fmac_f32 v152, v170, v10
    v_fmac_f32 v153, v170, v11
    v_lshlrev_b32 v10, 16, v89
    v_and_b32 v11, 0xffff0000, v89
    v_fmac_f32 v146, v162, v10
    v_fmac_f32 v147, v162, v11
    v_fmac_f32 v154, v170, v10
    v_fmac_f32 v155, v170, v11
    v_lshlrev_b32 v10, 16, v90
    v_and_b32 v11, 0xffff0000, v90
    v_fmac_f32 v148, v162, v10
    v_fmac_f32 v149, v162, v11
    v_fmac_f32 v156, v170, v10
    v_fmac_f32 v157, v170, v11
    v_lshlrev_b32 v10, 16, v91
    v_and_b32 v11, 0xffff0000, v91
    v_fmac_f32 v150, v162, v10
    v_fmac_f32 v151, v162, v11
    v_fmac_f32 v158, v170, v10
    v_fmac_f32 v159, v170, v11
    v_lshlrev_b32 v10, 16, v92
    v_and_b32 v11, 0xffff0000, v92
    v_fmac_f32 v144, v163, v10
    v_fmac_f32 v145, v163, v11
    v_fmac_f32 v152, v171, v10
    v_fmac_f32 v153, v171, v11
    v_lshlrev_b32 v10, 16, v93
    v_and_b32 v11, 0xffff0000, v93
    v_fmac_f32 v146, v163, v10
    v_fmac_f32 v147, v163, v11
    v_fmac_f32 v154, v171, v10
    v_fmac_f32 v155, v171, v11
    v_lshlrev_b32 v10, 16, v94
    v_and_b32 v11, 0xffff0000, v94
    v_fmac_f32 v148, v163, v10
    v_fmac_f32 v149, v163, v11
    v_fmac_f32 v156, v171, v10
    v_fmac_f32 v157, v171, v11
    v_lshlrev_b32 v10, 16, v95
    v_and_b32 v11, 0xffff0000, v95
    v_fmac_f32 v150, v163, v10
    v_fmac_f32 v151, v163, v11
    v_fmac_f32 v158, v171, v10
    v_fmac_f32 v159, v171, v11
    v_lshlrev_b32 v10, 16, v96
    v_and_b32 v11, 0xffff0000, v96
    v_fmac_f32 v144, v164, v10
    v_fmac_f32 v145, v164, v11
    v_fmac_f32 v152, v172, v10
    v_fmac_f32 v153, v172, v11
    v_lshlrev_b32 v10, 16, v97
    v_and_b32 v11, 0xffff0000, v97
    v_fmac_f32 v146, v164, v10
    v_fmac_f32 v147, v164, v11
    v_fmac_f32 v154, v172, v10
    v_fmac_f32 v155, v172, v11
    v_lshlrev_b32 v10, 16, v98
    v_and_b32 v11, 0xffff0000, v98
    v_fmac_f32 v148, v164, v10
    v_fmac_f32 v149, v164, v11
    v_fmac_f32 v156, v172, v10
    v_fmac_f32 v157, v172, v11
    v_lshlrev_b32 v10, 16, v99
    v_and_b32 v11, 0xffff0000, v99
    v_fmac_f32 v150, v164, v10
    v_fmac_f32 v151, v164, v11
    v_fmac_f32 v158, v172, v10
    v_fmac_f32 v159, v172, v11
    v_lshlrev_b32 v10, 16, v100
    v_and_b32 v11, 0xffff0000, v100
    v_fmac_f32 v144, v165, v10
    v_fmac_f32 v145, v165, v11
    v_fmac_f32 v152, v173, v10
    v_fmac_f32 v153, v173, v11
    v_lshlrev_b32 v10, 16, v101
    v_and_b32 v11, 0xffff0000, v101
    v_fmac_f32 v146, v165, v10
    v_fmac_f32 v147, v165, v11
    v_fmac_f32 v154, v173, v10
    v_fmac_f32 v155, v173, v11
    v_lshlrev_b32 v10, 16, v102
    v_and_b32 v11, 0xffff0000, v102
    v_fmac_f32 v148, v165, v10
    v_fmac_f32 v149, v165, v11
    v_fmac_f32 v156, v173, v10
    v_fmac_f32 v157, v173, v11
    v_lshlrev_b32 v10, 16, v103
    v_and_b32 v11, 0xffff0000, v103
    v_fmac_f32 v150, v165, v10
    v_fmac_f32 v151, v165, v11
    v_fmac_f32 v158, v173, v10
    v_fmac_f32 v159, v173, v11
    v_lshlrev_b32 v10, 16, v104
    v_and_b32 v11, 0xffff0000, v104
    v_fmac_f32 v144, v166, v10
    v_fmac_f32 v145, v166, v11
    v_fmac_f32 v152, v174, v10
    v_fmac_f32 v153, v174, v11
    v_lshlrev_b32 v10, 16, v105
    v_and_b32 v11, 0xffff0000, v105
    v_fmac_f32 v146, v166, v10
    v_fmac_f32 v147, v166, v11
    v_fmac_f32 v154, v174, v10
    v_fmac_f32 v155, v174, v11
    v_lshlrev_b32 v10, 16, v106
    v_and_b32 v11, 0xffff0000, v106
    v_fmac_f32 v148, v166, v10
    v_fmac_f32 v149, v166, v11
    v_fmac_f32 v156, v174, v10
    v_fmac_f32 v157, v174, v11
    v_lshlrev_b32 v10, 16, v107
    v_and_b32 v11, 0xffff0000, v107
    v_fmac_f32 v150, v166, v10
    v_fmac_f32 v151, v166, v11
    v_fmac_f32 v158, v174, v10
    v_fmac_f32 v159, v174, v11
    v_lshlrev_b32 v10, 16, v108
    v_and_b32 v11, 0xffff0000, v108
    v_fmac_f32 v144, v167, v10
    v_fmac_f32 v145, v167, v11
    v_fmac_f32 v152, v175, v10
    v_fmac_f32 v153, v175, v11
    v_lshlrev_b32 v10, 16, v109
    v_and_b32 v11, 0xffff0000, v109
    v_fmac_f32 v146, v167, v10
    v_fmac_f32 v147, v167, v11
    v_fmac_f32 v154, v175, v10
    v_fmac_f32 v155, v175, v11
    v_lshlrev_b32 v10, 16, v110
    v_and_b32 v11, 0xffff0000, v110
    v_fmac_f32 v148, v167, v10
    v_fmac_f32 v149, v167, v11
    v_fmac_f32 v156, v175, v10
    v_fmac_f32 v157, v175, v11
    v_lshlrev_b32 v10, 16, v111
    v_and_b32 v11, 0xffff0000, v111
    v_fmac_f32 v150, v167, v10
    v_fmac_f32 v151, v167, v11
    v_fmac_f32 v158, v175, v10
    v_fmac_f32 v159, v175, v11
    ds_read_b128 v[160:163], v9 offset:128
    ds_read_b128 v[164:167], v9 offset:144
    ds_read_b128 v[168:171], v9 offset:640
    ds_read_b128 v[172:175], v9 offset:656
    s_add_u32 s26, s25, 40960
    buffer_load_dwordx4 v[80:83], v3, s[16:19], s26 offen offset:0 nt
    buffer_load_dwordx4 v[84:87], v3, s[16:19], s26 offen offset:1024 nt
    buffer_load_dwordx4 v[88:91], v3, s[16:19], s26 offen offset:2048 nt
    buffer_load_dwordx4 v[92:95], v3, s[16:19], s26 offen offset:3072 nt
    s_add_u32 s26, s25, 45056
    buffer_load_dwordx4 v[96:99], v3, s[16:19], s26 offen offset:0 nt
    buffer_load_dwordx4 v[100:103], v3, s[16:19], s26 offen offset:1024 nt
    buffer_load_dwordx4 v[104:107], v3, s[16:19], s26 offen offset:2048 nt
    buffer_load_dwordx4 v[108:111], v3, s[16:19], s26 offen offset:3072 nt
    s_waitcnt vmcnt(8) lgkmcnt(0)
    v_lshlrev_b32 v10, 16, v48
    v_and_b32 v11, 0xffff0000, v48
    v_fmac_f32 v144, v160, v10
    v_fmac_f32 v145, v160, v11
    v_fmac_f32 v152, v168, v10
    v_fmac_f32 v153, v168, v11
    v_lshlrev_b32 v10, 16, v49
    v_and_b32 v11, 0xffff0000, v49
    v_fmac_f32 v146, v160, v10
    v_fmac_f32 v147, v160, v11
    v_fmac_f32 v154, v168, v10
    v_fmac_f32 v155, v168, v11
    v_lshlrev_b32 v10, 16, v50
    v_and_b32 v11, 0xffff0000, v50
    v_fmac_f32 v148, v160, v10
    v_fmac_f32 v149, v160, v11
    v_fmac_f32 v156, v168, v10
    v_fmac_f32 v157, v168, v11
    v_lshlrev_b32 v10, 16, v51
    v_and_b32 v11, 0xffff0000, v51
    v_fmac_f32 v150, v160, v10
    v_fmac_f32 v151, v160, v11
    v_fmac_f32 v158, v168, v10
    v_fmac_f32 v159, v168, v11
    v_lshlrev_b32 v10, 16, v52
    v_and_b32 v11, 0xffff0000, v52
    v_fmac_f32 v144, v161, v10
    v_fmac_f32 v145, v161, v11
    v_fmac_f32 v152, v169, v10
    v_fmac_f32 v153, v169, v11
    v_lshlrev_b32 v10, 16, v53
    v_and_b32 v11, 0xffff0000, v53
    v_fmac_f32 v146, v161, v10
    v_fmac_f32 v147, v161, v11
    v_fmac_f32 v154, v169, v10
    v_fmac_f32 v155, v169, v11
    v_lshlrev_b32 v10, 16, v54
    v_and_b32 v11, 0xffff0000, v54
    v_fmac_f32 v148, v161, v10
    v_fmac_f32 v149, v161, v11
    v_fmac_f32 v156, v169, v10
    v_fmac_f32 v157, v169, v11
    v_lshlrev_b32 v10, 16, v55
    v_and_b32 v11, 0xffff0000, v55
    v_fmac_f32 v150, v161, v10
    v_fmac_f32 v151, v161, v11
    v_fmac_f32 v158, v169, v10
    v_fmac_f32 v159, v169, v11
    v_lshlrev_b32 v10, 16, v56
    v_and_b32 v11, 0xffff0000, v56
    v_fmac_f32 v144, v162, v10
    v_fmac_f32 v145, v162, v11
    v_fmac_f32 v152, v170, v10
    v_fmac_f32 v153, v170, v11
    v_lshlrev_b32 v10, 16, v57
    v_and_b32 v11, 0xffff0000, v57
    v_fmac_f32 v146, v162, v10
    v_fmac_f32 v147, v162, v11
    v_fmac_f32 v154, v170, v10
    v_fmac_f32 v155, v170, v11
    v_lshlrev_b32 v10, 16, v58
    v_and_b32 v11, 0xffff0000, v58
    v_fmac_f32 v148, v162, v10
    v_fmac_f32 v149, v162, v11
    v_fmac_f32 v156, v170, v10
    v_fmac_f32 v157, v170, v11
    v_lshlrev_b32 v10, 16, v59
    v_and_b32 v11, 0xffff0000, v59
    v_fmac_f32 v150, v162, v10
    v_fmac_f32 v151, v162, v11
    v_fmac_f32 v158, v170, v10
    v_fmac_f32 v159, v170, v11
    v_lshlrev_b32 v10, 16, v60
    v_and_b32 v11, 0xffff0000, v60
    v_fmac_f32 v144, v163, v10
    v_fmac_f32 v145, v163, v11
    v_fmac_f32 v152, v171, v10
    v_fmac_f32 v153, v171, v11
    v_lshlrev_b32 v10, 16, v61
    v_and_b32 v11, 0xffff0000, v61
    v_fmac_f32 v146, v163, v10
    v_fmac_f32 v147, v163, v11
    v_fmac_f32 v154, v171, v10
    v_fmac_f32 v155, v171, v11
    v_lshlrev_b32 v10, 16, v62
    v_and_b32 v11, 0xffff0000, v62
    v_fmac_f32 v148, v163, v10
    v_fmac_f32 v149, v163, v11
    v_fmac_f32 v156, v171, v10
    v_fmac_f32 v157, v171, v11
    v_lshlrev_b32 v10, 16, v63
    v_and_b32 v11, 0xffff0000, v63
    v_fmac_f32 v150, v163, v10
    v_fmac_f32 v151, v163, v11
    v_fmac_f32 v158, v171, v10
    v_fmac_f32 v159, v171, v11
    v_lshlrev_b32 v10, 16, v64
    v_and_b32 v11, 0xffff0000, v64
    v_fmac_f32 v144, v164, v10
    v_fmac_f32 v145, v164, v11
    v_fmac_f32 v152, v172, v10
    v_fmac_f32 v153, v172, v11
    v_lshlrev_b32 v10, 16, v65
    v_and_b32 v11, 0xffff0000, v65
    v_fmac_f32 v146, v164, v10
    v_fmac_f32 v147, v164, v11
    v_fmac_f32 v154, v172, v10
    v_fmac_f32 v155, v172, v11
    v_lshlrev_b32 v10, 16, v66
    v_and_b32 v11, 0xffff0000, v66
    v_fmac_f32 v148, v164, v10
    v_fmac_f32 v149, v164, v11
    v_fmac_f32 v156, v172, v10
    v_fmac_f32 v157, v172, v11
    v_lshlrev_b32 v10, 16, v67
    v_and_b32 v11, 0xffff0000, v67
    v_fmac_f32 v150, v164, v10
    v_fmac_f32 v151, v164, v11
    v_fmac_f32 v158, v172, v10
    v_fmac_f32 v159, v172, v11
    v_lshlrev_b32 v10, 16, v68
    v_and_b32 v11, 0xffff0000, v68
    v_fmac_f32 v144, v165, v10
    v_fmac_f32 v145, v165, v11
    v_fmac_f32 v152, v173, v10
    v_fmac_f32 v153, v173, v11
    v_lshlrev_b32 v10, 16, v69
    v_and_b32 v11, 0xffff0000, v69
    v_fmac_f32 v146, v165, v10
    v_fmac_f32 v147, v165, v11
    v_fmac_f32 v154, v173, v10
    v_fmac_f32 v155, v173, v11
    v_lshlrev_b32 v10, 16, v70
    v_and_b32 v11, 0xffff0000, v70
    v_fmac_f32 v148, v165, v10
    v_fmac_f32 v149, v165, v11
    v_fmac_f32 v156, v173, v10
    v_fmac_f32 v157, v173, v11
    v_lshlrev_b32 v10, 16, v71
    v_and_b32 v11, 0xffff0000, v71
    v_fmac_f32 v150, v165, v10
    v_fmac_f32 v151, v165, v11
    v_fmac_f32 v158, v173, v10
    v_fmac_f32 v159, v173, v11
    v_lshlrev_b32 v10, 16, v72
    v_and_b32 v11, 0xffff0000, v72
    v_fmac_f32 v144, v166, v10
    v_fmac_f32 v145, v166, v11
    v_fmac_f32 v152, v174, v10
    v_fmac_f32 v153, v174, v11
    v_lshlrev_b32 v10, 16, v73
    v_and_b32 v11, 0xffff0000, v73
    v_fmac_f32 v146, v166, v10
    v_fmac_f32 v147, v166, v11
    v_fmac_f32 v154, v174, v10
    v_fmac_f32 v155, v174, v11
    v_lshlrev_b32 v10, 16, v74
    v_and_b32 v11, 0xffff0000, v74
    v_fmac_f32 v148, v166, v10
    v_fmac_f32 v149, v166, v11
    v_fmac_f32 v156, v174, v10
    v_fmac_f32 v157, v174, v11
    v_lshlrev_b32 v10, 16, v75
    v_and_b32 v11, 0xffff0000, v75
    v_fmac_f32 v150, v166, v10
    v_fmac_f32 v151, v166, v11
    v_fmac_f32 v158, v174, v10
    v_fmac_f32 v159, v174, v11
    v_lshlrev_b32 v10, 16, v76
    v_and_b32 v11, 0xffff0000, v76
    v_fmac_f32 v144, v167, v10
    v_fmac_f32 v145, v167, v11
    v_fmac_f32 v152, v175, v10
    v_fmac_f32 v153, v175, v11
    v_lshlrev_b32 v10, 16, v77
    v_and_b32 v11, 0xffff0000, v77
    v_fmac_f32 v146, v167, v10
    v_fmac_f32 v147, v167, v11
    v_fmac_f32 v154, v175, v10
    v_fmac_f32 v155, v175, v11
    v_lshlrev_b32 v10, 16, v78
    v_and_b32 v11, 0xffff0000, v78
    v_fmac_f32 v148, v167, v10
    v_fmac_f32 v149, v167, v11
    v_fmac_f32 v156, v175, v10
    v_fmac_f32 v157, v175, v11
    v_lshlrev_b32 v10, 16, v79
    v_and_b32 v11, 0xffff0000, v79
    v_fmac_f32 v150, v167, v10
    v_fmac_f32 v151, v167, v11
    v_fmac_f32 v158, v175, v10
    v_fmac_f32 v159, v175, v11
    ds_read_b128 v[160:163], v9 offset:160
    ds_read_b128 v[164:167], v9 offset:176
    ds_read_b128 v[168:171], v9 offset:672
    ds_read_b128 v[172:175], v9 offset:688
    s_add_u32 s26, s25, 49152
    buffer_load_dwordx4 v[48:51], v3, s[16:19], s26 offen offset:0 nt
    buffer_load_dwordx4 v[52:55], v3, s[16:19], s26 offen offset:1024 nt
    buffer_load_dwordx4 v[56:59], v3, s[16:19], s26 offen offset:2048 nt
    buffer_load_dwordx4 v[60:63], v3, s[16:19], s26 offen offset:3072 nt
    s_add_u32 s26, s25, 53248
    buffer_load_dwordx4 v[64:67], v3, s[16:19], s26 offen offset:0 nt
    buffer_load_dwordx4 v[68:71], v3, s[16:19], s26 offen offset:1024 nt
    buffer_load_dwordx4 v[72:75], v3, s[16:19], s26 offen offset:2048 nt
    buffer_load_dwordx4 v[76:79], v3, s[16:19], s26 offen offset:3072 nt
    s_waitcnt vmcnt(8) lgkmcnt(0)
    v_lshlrev_b32 v10, 16, v80
    v_and_b32 v11, 0xffff0000, v80
    v_fmac_f32 v144, v160, v10
    v_fmac_f32 v145, v160, v11
    v_fmac_f32 v152, v168, v10
    v_fmac_f32 v153, v168, v11
    v_lshlrev_b32 v10, 16, v81
    v_and_b32 v11, 0xffff0000, v81
    v_fmac_f32 v146, v160, v10
    v_fmac_f32 v147, v160, v11
    v_fmac_f32 v154, v168, v10
    v_fmac_f32 v155, v168, v11
    v_lshlrev_b32 v10, 16, v82
    v_and_b32 v11, 0xffff0000, v82
    v_fmac_f32 v148, v160, v10
    v_fmac_f32 v149, v160, v11
    v_fmac_f32 v156, v168, v10
    v_fmac_f32 v157, v168, v11
    v_lshlrev_b32 v10, 16, v83
    v_and_b32 v11, 0xffff0000, v83
    v_fmac_f32 v150, v160, v10
    v_fmac_f32 v151, v160, v11
    v_fmac_f32 v158, v168, v10
    v_fmac_f32 v159, v168, v11
    v_lshlrev_b32 v10, 16, v84
    v_and_b32 v11, 0xffff0000, v84
    v_fmac_f32 v144, v161, v10
    v_fmac_f32 v145, v161, v11
    v_fmac_f32 v152, v169, v10
    v_fmac_f32 v153, v169, v11
    v_lshlrev_b32 v10, 16, v85
    v_and_b32 v11, 0xffff0000, v85
    v_fmac_f32 v146, v161, v10
    v_fmac_f32 v147, v161, v11
    v_fmac_f32 v154, v169, v10
    v_fmac_f32 v155, v169, v11
    v_lshlrev_b32 v10, 16, v86
    v_and_b32 v11, 0xffff0000, v86
    v_fmac_f32 v148, v161, v10
    v_fmac_f32 v149, v161, v11
    v_fmac_f32 v156, v169, v10
    v_fmac_f32 v157, v169, v11
    v_lshlrev_b32 v10, 16, v87
    v_and_b32 v11, 0xffff0000, v87
    v_fmac_f32 v150, v161, v10
    v_fmac_f32 v151, v161, v11
    v_fmac_f32 v158, v169, v10
    v_fmac_f32 v159, v169, v11
    v_lshlrev_b32 v10, 16, v88
    v_and_b32 v11, 0xffff0000, v88
    v_fmac_f32 v144, v162, v10
    v_fmac_f32 v145, v162, v11
    v_fmac_f32 v152, v170, v10
    v_fmac_f32 v153, v170, v11
    v_lshlrev_b32 v10, 16, v89
    v_and_b32 v11, 0xffff0000, v89
    v_fmac_f32 v146, v162, v10
    v_fmac_f32 v147, v162, v11
    v_fmac_f32 v154, v170, v10
    v_fmac_f32 v155, v170, v11
    v_lshlrev_b32 v10, 16, v90
    v_and_b32 v11, 0xffff0000, v90
    v_fmac_f32 v148, v162, v10
    v_fmac_f32 v149, v162, v11
    v_fmac_f32 v156, v170, v10
    v_fmac_f32 v157, v170, v11
    v_lshlrev_b32 v10, 16, v91
    v_and_b32 v11, 0xffff0000, v91
    v_fmac_f32 v150, v162, v10
    v_fmac_f32 v151, v162, v11
    v_fmac_f32 v158, v170, v10
    v_fmac_f32 v159, v170, v11
    v_lshlrev_b32 v10, 16, v92
    v_and_b32 v11, 0xffff0000, v92
    v_fmac_f32 v144, v163, v10
    v_fmac_f32 v145, v163, v11
    v_fmac_f32 v152, v171, v10
    v_fmac_f32 v153, v171, v11
    v_lshlrev_b32 v10, 16, v93
    v_and_b32 v11, 0xffff0000, v93
    v_fmac_f32 v146, v163, v10
    v_fmac_f32 v147, v163, v11
    v_fmac_f32 v154, v171, v10
    v_fmac_f32 v155, v171, v11
    v_lshlrev_b32 v10, 16, v94
    v_and_b32 v11, 0xffff0000, v94
    v_fmac_f32 v148, v163, v10
    v_fmac_f32 v149, v163, v11
    v_fmac_f32 v156, v171, v10
    v_fmac_f32 v157, v171, v11
    v_lshlrev_b32 v10, 16, v95
    v_and_b32 v11, 0xffff0000, v95
    v_fmac_f32 v150, v163, v10
    v_fmac_f32 v151, v163, v11
    v_fmac_f32 v158, v171, v10
    v_fmac_f32 v159, v171, v11
    v_lshlrev_b32 v10, 16, v96
    v_and_b32 v11, 0xffff0000, v96
    v_fmac_f32 v144, v164, v10
    v_fmac_f32 v145, v164, v11
    v_fmac_f32 v152, v172, v10
    v_fmac_f32 v153, v172, v11
    v_lshlrev_b32 v10, 16, v97
    v_and_b32 v11, 0xffff0000, v97
    v_fmac_f32 v146, v164, v10
    v_fmac_f32 v147, v164, v11
    v_fmac_f32 v154, v172, v10
    v_fmac_f32 v155, v172, v11
    v_lshlrev_b32 v10, 16, v98
    v_and_b32 v11, 0xffff0000, v98
    v_fmac_f32 v148, v164, v10
    v_fmac_f32 v149, v164, v11
    v_fmac_f32 v156, v172, v10
    v_fmac_f32 v157, v172, v11
    v_lshlrev_b32 v10, 16, v99
    v_and_b32 v11, 0xffff0000, v99
    v_fmac_f32 v150, v164, v10
    v_fmac_f32 v151, v164, v11
    v_fmac_f32 v158, v172, v10
    v_fmac_f32 v159, v172, v11
    v_lshlrev_b32 v10, 16, v100
    v_and_b32 v11, 0xffff0000, v100
    v_fmac_f32 v144, v165, v10
    v_fmac_f32 v145, v165, v11
    v_fmac_f32 v152, v173, v10
    v_fmac_f32 v153, v173, v11
    v_lshlrev_b32 v10, 16, v101
    v_and_b32 v11, 0xffff0000, v101
    v_fmac_f32 v146, v165, v10
    v_fmac_f32 v147, v165, v11
    v_fmac_f32 v154, v173, v10
    v_fmac_f32 v155, v173, v11
    v_lshlrev_b32 v10, 16, v102
    v_and_b32 v11, 0xffff0000, v102
    v_fmac_f32 v148, v165, v10
    v_fmac_f32 v149, v165, v11
    v_fmac_f32 v156, v173, v10
    v_fmac_f32 v157, v173, v11
    v_lshlrev_b32 v10, 16, v103
    v_and_b32 v11, 0xffff0000, v103
    v_fmac_f32 v150, v165, v10
    v_fmac_f32 v151, v165, v11
    v_fmac_f32 v158, v173, v10
    v_fmac_f32 v159, v173, v11
    v_lshlrev_b32 v10, 16, v104
    v_and_b32 v11, 0xffff0000, v104
    v_fmac_f32 v144, v166, v10
    v_fmac_f32 v145, v166, v11
    v_fmac_f32 v152, v174, v10
    v_fmac_f32 v153, v174, v11
    v_lshlrev_b32 v10, 16, v105
    v_and_b32 v11, 0xffff0000, v105
    v_fmac_f32 v146, v166, v10
    v_fmac_f32 v147, v166, v11
    v_fmac_f32 v154, v174, v10
    v_fmac_f32 v155, v174, v11
    v_lshlrev_b32 v10, 16, v106
    v_and_b32 v11, 0xffff0000, v106
    v_fmac_f32 v148, v166, v10
    v_fmac_f32 v149, v166, v11
    v_fmac_f32 v156, v174, v10
    v_fmac_f32 v157, v174, v11
    v_lshlrev_b32 v10, 16, v107
    v_and_b32 v11, 0xffff0000, v107
    v_fmac_f32 v150, v166, v10
    v_fmac_f32 v151, v166, v11
    v_fmac_f32 v158, v174, v10
    v_fmac_f32 v159, v174, v11
    v_lshlrev_b32 v10, 16, v108
    v_and_b32 v11, 0xffff0000, v108
    v_fmac_f32 v144, v167, v10
    v_fmac_f32 v145, v167, v11
    v_fmac_f32 v152, v175, v10
    v_fmac_f32 v153, v175, v11
    v_lshlrev_b32 v10, 16, v109
    v_and_b32 v11, 0xffff0000, v109
    v_fmac_f32 v146, v167, v10
    v_fmac_f32 v147, v167, v11
    v_fmac_f32 v154, v175, v10
    v_fmac_f32 v155, v175, v11
    v_lshlrev_b32 v10, 16, v110
    v_and_b32 v11, 0xffff0000, v110
    v_fmac_f32 v148, v167, v10
    v_fmac_f32 v149, v167, v11
    v_fmac_f32 v156, v175, v10
    v_fmac_f32 v157, v175, v11
    v_lshlrev_b32 v10, 16, v111
    v_and_b32 v11, 0xffff0000, v111
    v_fmac_f32 v150, v167, v10
    v_fmac_f32 v151, v167, v11
    v_fmac_f32 v158, v175, v10
    v_fmac_f32 v159, v175, v11
    ds_read_b128 v[160:163], v9 offset:192
    ds_read_b128 v[164:167], v9 offset:208
    ds_read_b128 v[168:171], v9 offset:704
    ds_read_b128 v[172:175], v9 offset:720
    s_add_u32 s26, s25, 57344
    buffer_load_dwordx4 v[80:83], v3, s[16:19], s26 offen offset:0 nt
    buffer_load_dwordx4 v[84:87], v3, s[16:19], s26 offen offset:1024 nt
    buffer_load_dwordx4 v[88:91], v3, s[16:19], s26 offen offset:2048 nt
    buffer_load_dwordx4 v[92:95], v3, s[16:19], s26 offen offset:3072 nt
    s_add_u32 s26, s25, 61440
    buffer_load_dwordx4 v[96:99], v3, s[16:19], s26 offen offset:0 nt
    buffer_load_dwordx4 v[100:103], v3, s[16:19], s26 offen offset:1024 nt
    buffer_load_dwordx4 v[104:107], v3, s[16:19], s26 offen offset:2048 nt
    buffer_load_dwordx4 v[108:111], v3, s[16:19], s26 offen offset:3072 nt
    s_waitcnt vmcnt(8) lgkmcnt(0)
    v_lshlrev_b32 v10, 16, v48
    v_and_b32 v11, 0xffff0000, v48
    v_fmac_f32 v144, v160, v10
    v_fmac_f32 v145, v160, v11
    v_fmac_f32 v152, v168, v10
    v_fmac_f32 v153, v168, v11
    v_lshlrev_b32 v10, 16, v49
    v_and_b32 v11, 0xffff0000, v49
    v_fmac_f32 v146, v160, v10
    v_fmac_f32 v147, v160, v11
    v_fmac_f32 v154, v168, v10
    v_fmac_f32 v155, v168, v11
    v_lshlrev_b32 v10, 16, v50
    v_and_b32 v11, 0xffff0000, v50
    v_fmac_f32 v148, v160, v10
    v_fmac_f32 v149, v160, v11
    v_fmac_f32 v156, v168, v10
    v_fmac_f32 v157, v168, v11
    v_lshlrev_b32 v10, 16, v51
    v_and_b32 v11, 0xffff0000, v51
    v_fmac_f32 v150, v160, v10
    v_fmac_f32 v151, v160, v11
    v_fmac_f32 v158, v168, v10
    v_fmac_f32 v159, v168, v11
    v_lshlrev_b32 v10, 16, v52
    v_and_b32 v11, 0xffff0000, v52
    v_fmac_f32 v144, v161, v10
    v_fmac_f32 v145, v161, v11
    v_fmac_f32 v152, v169, v10
    v_fmac_f32 v153, v169, v11
    v_lshlrev_b32 v10, 16, v53
    v_and_b32 v11, 0xffff0000, v53
    v_fmac_f32 v146, v161, v10
    v_fmac_f32 v147, v161, v11
    v_fmac_f32 v154, v169, v10
    v_fmac_f32 v155, v169, v11
    v_lshlrev_b32 v10, 16, v54
    v_and_b32 v11, 0xffff0000, v54
    v_fmac_f32 v148, v161, v10
    v_fmac_f32 v149, v161, v11
    v_fmac_f32 v156, v169, v10
    v_fmac_f32 v157, v169, v11
    v_lshlrev_b32 v10, 16, v55
    v_and_b32 v11, 0xffff0000, v55
    v_fmac_f32 v150, v161, v10
    v_fmac_f32 v151, v161, v11
    v_fmac_f32 v158, v169, v10
    v_fmac_f32 v159, v169, v11
    v_lshlrev_b32 v10, 16, v56
    v_and_b32 v11, 0xffff0000, v56
    v_fmac_f32 v144, v162, v10
    v_fmac_f32 v145, v162, v11
    v_fmac_f32 v152, v170, v10
    v_fmac_f32 v153, v170, v11
    v_lshlrev_b32 v10, 16, v57
    v_and_b32 v11, 0xffff0000, v57
    v_fmac_f32 v146, v162, v10
    v_fmac_f32 v147, v162, v11
    v_fmac_f32 v154, v170, v10
    v_fmac_f32 v155, v170, v11
    v_lshlrev_b32 v10, 16, v58
    v_and_b32 v11, 0xffff0000, v58
    v_fmac_f32 v148, v162, v10
    v_fmac_f32 v149, v162, v11
    v_fmac_f32 v156, v170, v10
    v_fmac_f32 v157, v170, v11
    v_lshlrev_b32 v10, 16, v59
    v_and_b32 v11, 0xffff0000, v59
    v_fmac_f32 v150, v162, v10
    v_fmac_f32 v151, v162, v11
    v_fmac_f32 v158, v170, v10
    v_fmac_f32 v159, v170, v11
    v_lshlrev_b32 v10, 16, v60
    v_and_b32 v11, 0xffff0000, v60
    v_fmac_f32 v144, v163, v10
    v_fmac_f32 v145, v163, v11
    v_fmac_f32 v152, v171, v10
    v_fmac_f32 v153, v171, v11
    v_lshlrev_b32 v10, 16, v61
    v_and_b32 v11, 0xffff0000, v61
    v_fmac_f32 v146, v163, v10
    v_fmac_f32 v147, v163, v11
    v_fmac_f32 v154, v171, v10
    v_fmac_f32 v155, v171, v11
    v_lshlrev_b32 v10, 16, v62
    v_and_b32 v11, 0xffff0000, v62
    v_fmac_f32 v148, v163, v10
    v_fmac_f32 v149, v163, v11
    v_fmac_f32 v156, v171, v10
    v_fmac_f32 v157, v171, v11
    v_lshlrev_b32 v10, 16, v63
    v_and_b32 v11, 0xffff0000, v63
    v_fmac_f32 v150, v163, v10
    v_fmac_f32 v151, v163, v11
    v_fmac_f32 v158, v171, v10
    v_fmac_f32 v159, v171, v11
    v_lshlrev_b32 v10, 16, v64
    v_and_b32 v11, 0xffff0000, v64
    v_fmac_f32 v144, v164, v10
    v_fmac_f32 v145, v164, v11
    v_fmac_f32 v152, v172, v10
    v_fmac_f32 v153, v172, v11
    v_lshlrev_b32 v10, 16, v65
    v_and_b32 v11, 0xffff0000, v65
    v_fmac_f32 v146, v164, v10
    v_fmac_f32 v147, v164, v11
    v_fmac_f32 v154, v172, v10
    v_fmac_f32 v155, v172, v11
    v_lshlrev_b32 v10, 16, v66
    v_and_b32 v11, 0xffff0000, v66
    v_fmac_f32 v148, v164, v10
    v_fmac_f32 v149, v164, v11
    v_fmac_f32 v156, v172, v10
    v_fmac_f32 v157, v172, v11
    v_lshlrev_b32 v10, 16, v67
    v_and_b32 v11, 0xffff0000, v67
    v_fmac_f32 v150, v164, v10
    v_fmac_f32 v151, v164, v11
    v_fmac_f32 v158, v172, v10
    v_fmac_f32 v159, v172, v11
    v_lshlrev_b32 v10, 16, v68
    v_and_b32 v11, 0xffff0000, v68
    v_fmac_f32 v144, v165, v10
    v_fmac_f32 v145, v165, v11
    v_fmac_f32 v152, v173, v10
    v_fmac_f32 v153, v173, v11
    v_lshlrev_b32 v10, 16, v69
    v_and_b32 v11, 0xffff0000, v69
    v_fmac_f32 v146, v165, v10
    v_fmac_f32 v147, v165, v11
    v_fmac_f32 v154, v173, v10
    v_fmac_f32 v155, v173, v11
    v_lshlrev_b32 v10, 16, v70
    v_and_b32 v11, 0xffff0000, v70
    v_fmac_f32 v148, v165, v10
    v_fmac_f32 v149, v165, v11
    v_fmac_f32 v156, v173, v10
    v_fmac_f32 v157, v173, v11
    v_lshlrev_b32 v10, 16, v71
    v_and_b32 v11, 0xffff0000, v71
    v_fmac_f32 v150, v165, v10
    v_fmac_f32 v151, v165, v11
    v_fmac_f32 v158, v173, v10
    v_fmac_f32 v159, v173, v11
    v_lshlrev_b32 v10, 16, v72
    v_and_b32 v11, 0xffff0000, v72
    v_fmac_f32 v144, v166, v10
    v_fmac_f32 v145, v166, v11
    v_fmac_f32 v152, v174, v10
    v_fmac_f32 v153, v174, v11
    v_lshlrev_b32 v10, 16, v73
    v_and_b32 v11, 0xffff0000, v73
    v_fmac_f32 v146, v166, v10
    v_fmac_f32 v147, v166, v11
    v_fmac_f32 v154, v174, v10
    v_fmac_f32 v155, v174, v11
    v_lshlrev_b32 v10, 16, v74
    v_and_b32 v11, 0xffff0000, v74
    v_fmac_f32 v148, v166, v10
    v_fmac_f32 v149, v166, v11
    v_fmac_f32 v156, v174, v10
    v_fmac_f32 v157, v174, v11
    v_lshlrev_b32 v10, 16, v75
    v_and_b32 v11, 0xffff0000, v75
    v_fmac_f32 v150, v166, v10
    v_fmac_f32 v151, v166, v11
    v_fmac_f32 v158, v174, v10
    v_fmac_f32 v159, v174, v11
    v_lshlrev_b32 v10, 16, v76
    v_and_b32 v11, 0xffff0000, v76
    v_fmac_f32 v144, v167, v10
    v_fmac_f32 v145, v167, v11
    v_fmac_f32 v152, v175, v10
    v_fmac_f32 v153, v175, v11
    v_lshlrev_b32 v10, 16, v77
    v_and_b32 v11, 0xffff0000, v77
    v_fmac_f32 v146, v167, v10
    v_fmac_f32 v147, v167, v11
    v_fmac_f32 v154, v175, v10
    v_fmac_f32 v155, v175, v11
    v_lshlrev_b32 v10, 16, v78
    v_and_b32 v11, 0xffff0000, v78
    v_fmac_f32 v148, v167, v10
    v_fmac_f32 v149, v167, v11
    v_fmac_f32 v156, v175, v10
    v_fmac_f32 v157, v175, v11
    v_lshlrev_b32 v10, 16, v79
    v_and_b32 v11, 0xffff0000, v79
    v_fmac_f32 v150, v167, v10
    v_fmac_f32 v151, v167, v11
    v_fmac_f32 v158, v175, v10
    v_fmac_f32 v159, v175, v11
    ds_read_b128 v[160:163], v9 offset:224
    ds_read_b128 v[164:167], v9 offset:240
    ds_read_b128 v[168:171], v9 offset:736
    ds_read_b128 v[172:175], v9 offset:752
    s_waitcnt vmcnt(0) lgkmcnt(0)
    v_lshlrev_b32 v10, 16, v80
    v_and_b32 v11, 0xffff0000, v80
    v_fmac_f32 v144, v160, v10
    v_fmac_f32 v145, v160, v11
    v_fmac_f32 v152, v168, v10
    v_fmac_f32 v153, v168, v11
    v_lshlrev_b32 v10, 16, v81
    v_and_b32 v11, 0xffff0000, v81
    v_fmac_f32 v146, v160, v10
    v_fmac_f32 v147, v160, v11
    v_fmac_f32 v154, v168, v10
    v_fmac_f32 v155, v168, v11
    v_lshlrev_b32 v10, 16, v82
    v_and_b32 v11, 0xffff0000, v82
    v_fmac_f32 v148, v160, v10
    v_fmac_f32 v149, v160, v11
    v_fmac_f32 v156, v168, v10
    v_fmac_f32 v157, v168, v11
    v_lshlrev_b32 v10, 16, v83
    v_and_b32 v11, 0xffff0000, v83
    v_fmac_f32 v150, v160, v10
    v_fmac_f32 v151, v160, v11
    v_fmac_f32 v158, v168, v10
    v_fmac_f32 v159, v168, v11
    v_lshlrev_b32 v10, 16, v84
    v_and_b32 v11, 0xffff0000, v84
    v_fmac_f32 v144, v161, v10
    v_fmac_f32 v145, v161, v11
    v_fmac_f32 v152, v169, v10
    v_fmac_f32 v153, v169, v11
    v_lshlrev_b32 v10, 16, v85
    v_and_b32 v11, 0xffff0000, v85
    v_fmac_f32 v146, v161, v10
    v_fmac_f32 v147, v161, v11
    v_fmac_f32 v154, v169, v10
    v_fmac_f32 v155, v169, v11
    v_lshlrev_b32 v10, 16, v86
    v_and_b32 v11, 0xffff0000, v86
    v_fmac_f32 v148, v161, v10
    v_fmac_f32 v149, v161, v11
    v_fmac_f32 v156, v169, v10
    v_fmac_f32 v157, v169, v11
    v_lshlrev_b32 v10, 16, v87
    v_and_b32 v11, 0xffff0000, v87
    v_fmac_f32 v150, v161, v10
    v_fmac_f32 v151, v161, v11
    v_fmac_f32 v158, v169, v10
    v_fmac_f32 v159, v169, v11
    v_lshlrev_b32 v10, 16, v88
    v_and_b32 v11, 0xffff0000, v88
    v_fmac_f32 v144, v162, v10
    v_fmac_f32 v145, v162, v11
    v_fmac_f32 v152, v170, v10
    v_fmac_f32 v153, v170, v11
    v_lshlrev_b32 v10, 16, v89
    v_and_b32 v11, 0xffff0000, v89
    v_fmac_f32 v146, v162, v10
    v_fmac_f32 v147, v162, v11
    v_fmac_f32 v154, v170, v10
    v_fmac_f32 v155, v170, v11
    v_lshlrev_b32 v10, 16, v90
    v_and_b32 v11, 0xffff0000, v90
    v_fmac_f32 v148, v162, v10
    v_fmac_f32 v149, v162, v11
    v_fmac_f32 v156, v170, v10
    v_fmac_f32 v157, v170, v11
    v_lshlrev_b32 v10, 16, v91
    v_and_b32 v11, 0xffff0000, v91
    v_fmac_f32 v150, v162, v10
    v_fmac_f32 v151, v162, v11
    v_fmac_f32 v158, v170, v10
    v_fmac_f32 v159, v170, v11
    v_lshlrev_b32 v10, 16, v92
    v_and_b32 v11, 0xffff0000, v92
    v_fmac_f32 v144, v163, v10
    v_fmac_f32 v145, v163, v11
    v_fmac_f32 v152, v171, v10
    v_fmac_f32 v153, v171, v11
    v_lshlrev_b32 v10, 16, v93
    v_and_b32 v11, 0xffff0000, v93
    v_fmac_f32 v146, v163, v10
    v_fmac_f32 v147, v163, v11
    v_fmac_f32 v154, v171, v10
    v_fmac_f32 v155, v171, v11
    v_lshlrev_b32 v10, 16, v94
    v_and_b32 v11, 0xffff0000, v94
    v_fmac_f32 v148, v163, v10
    v_fmac_f32 v149, v163, v11
    v_fmac_f32 v156, v171, v10
    v_fmac_f32 v157, v171, v11
    v_lshlrev_b32 v10, 16, v95
    v_and_b32 v11, 0xffff0000, v95
    v_fmac_f32 v150, v163, v10
    v_fmac_f32 v151, v163, v11
    v_fmac_f32 v158, v171, v10
    v_fmac_f32 v159, v171, v11
    v_lshlrev_b32 v10, 16, v96
    v_and_b32 v11, 0xffff0000, v96
    v_fmac_f32 v144, v164, v10
    v_fmac_f32 v145, v164, v11
    v_fmac_f32 v152, v172, v10
    v_fmac_f32 v153, v172, v11
    v_lshlrev_b32 v10, 16, v97
    v_and_b32 v11, 0xffff0000, v97
    v_fmac_f32 v146, v164, v10
    v_fmac_f32 v147, v164, v11
    v_fmac_f32 v154, v172, v10
    v_fmac_f32 v155, v172, v11
    v_lshlrev_b32 v10, 16, v98
    v_and_b32 v11, 0xffff0000, v98
    v_fmac_f32 v148, v164, v10
    v_fmac_f32 v149, v164, v11
    v_fmac_f32 v156, v172, v10
    v_fmac_f32 v157, v172, v11
    v_lshlrev_b32 v10, 16, v99
    v_and_b32 v11, 0xffff0000, v99
    v_fmac_f32 v150, v164, v10
    v_fmac_f32 v151, v164, v11
    v_fmac_f32 v158, v172, v10
    v_fmac_f32 v159, v172, v11
    v_lshlrev_b32 v10, 16, v100
    v_and_b32 v11, 0xffff0000, v100
    v_fmac_f32 v144, v165, v10
    v_fmac_f32 v145, v165, v11
    v_fmac_f32 v152, v173, v10
    v_fmac_f32 v153, v173, v11
    v_lshlrev_b32 v10, 16, v101
    v_and_b32 v11, 0xffff0000, v101
    v_fmac_f32 v146, v165, v10
    v_fmac_f32 v147, v165, v11
    v_fmac_f32 v154, v173, v10
    v_fmac_f32 v155, v173, v11
    v_lshlrev_b32 v10, 16, v102
    v_and_b32 v11, 0xffff0000, v102
    v_fmac_f32 v148, v165, v10
    v_fmac_f32 v149, v165, v11
    v_fmac_f32 v156, v173, v10
    v_fmac_f32 v157, v173, v11
    v_lshlrev_b32 v10, 16, v103
    v_and_b32 v11, 0xffff0000, v103
    v_fmac_f32 v150, v165, v10
    v_fmac_f32 v151, v165, v11
    v_fmac_f32 v158, v173, v10
    v_fmac_f32 v159, v173, v11
    v_lshlrev_b32 v10, 16, v104
    v_and_b32 v11, 0xffff0000, v104
    v_fmac_f32 v144, v166, v10
    v_fmac_f32 v145, v166, v11
    v_fmac_f32 v152, v174, v10
    v_fmac_f32 v153, v174, v11
    v_lshlrev_b32 v10, 16, v105
    v_and_b32 v11, 0xffff0000, v105
    v_fmac_f32 v146, v166, v10
    v_fmac_f32 v147, v166, v11
    v_fmac_f32 v154, v174, v10
    v_fmac_f32 v155, v174, v11
    v_lshlrev_b32 v10, 16, v106
    v_and_b32 v11, 0xffff0000, v106
    v_fmac_f32 v148, v166, v10
    v_fmac_f32 v149, v166, v11
    v_fmac_f32 v156, v174, v10
    v_fmac_f32 v157, v174, v11
    v_lshlrev_b32 v10, 16, v107
    v_and_b32 v11, 0xffff0000, v107
    v_fmac_f32 v150, v166, v10
    v_fmac_f32 v151, v166, v11
    v_fmac_f32 v158, v174, v10
    v_fmac_f32 v159, v174, v11
    v_lshlrev_b32 v10, 16, v108
    v_and_b32 v11, 0xffff0000, v108
    v_fmac_f32 v144, v167, v10
    v_fmac_f32 v145, v167, v11
    v_fmac_f32 v152, v175, v10
    v_fmac_f32 v153, v175, v11
    v_lshlrev_b32 v10, 16, v109
    v_and_b32 v11, 0xffff0000, v109
    v_fmac_f32 v146, v167, v10
    v_fmac_f32 v147, v167, v11
    v_fmac_f32 v154, v175, v10
    v_fmac_f32 v155, v175, v11
    v_lshlrev_b32 v10, 16, v110
    v_and_b32 v11, 0xffff0000, v110
    v_fmac_f32 v148, v167, v10
    v_fmac_f32 v149, v167, v11
    v_fmac_f32 v156, v175, v10
    v_fmac_f32 v157, v175, v11
    v_lshlrev_b32 v10, 16, v111
    v_and_b32 v11, 0xffff0000, v111
    v_fmac_f32 v150, v167, v10
    v_fmac_f32 v151, v167, v11
    v_fmac_f32 v158, v175, v10
    v_fmac_f32 v159, v175, v11
    v_lshrrev_b32 v10, 5, v0
    v_lshlrev_b32 v10, 11, v10
    v_and_b32 v11, 31, v1
    v_lshlrev_b32 v11, 5, v11
    v_add_u32 v10, v10, v11
    ds_write_b128 v10, v[144:147] offset:4096
    ds_write_b128 v10, v[148:151] offset:4112
    ds_write_b128 v10, v[152:155] offset:5120
    ds_write_b128 v10, v[156:159] offset:5136
    s_lshl_b32 s36, s24, 4
    v_mov_b32 v10, s36
    v_mov_b32 v12, s32
    v_mov_b32 v13, s34
    v_mov_b32 v14, s33
    v_mov_b32 v15, s35
    ds_write_b128 v10, v[12:15] offset:20480
    s_waitcnt lgkmcnt(0)
    s_barrier
    v_mov_b32 v10, 0
    ds_read_b128 v[16:19], v10 offset:20480
    ds_read_b128 v[20:23], v10 offset:20496
    ds_read_b128 v[24:27], v10 offset:20512
    ds_read_b128 v[28:31], v10 offset:20528
    v_lshlrev_b32 v11, 2, v0
    ds_read_b32 v32, v11 offset:4096
    ds_read_b32 v33, v11 offset:6144
    ds_read_b32 v34, v11 offset:8192
    ds_read_b32 v35, v11 offset:10240
    ds_read_b32 v36, v11 offset:12288
    ds_read_b32 v37, v11 offset:14336
    ds_read_b32 v38, v11 offset:16384
    ds_read_b32 v39, v11 offset:18432
    ds_read_b32 v40, v11 offset:5120
    ds_read_b32 v41, v11 offset:7168
    ds_read_b32 v42, v11 offset:9216
    ds_read_b32 v43, v11 offset:11264
    ds_read_b32 v44, v11 offset:13312
    ds_read_b32 v45, v11 offset:15360
    ds_read_b32 v46, v11 offset:17408
    ds_read_b32 v47, v11 offset:19456
    s_waitcnt lgkmcnt(0)
    s_lshl_b32 s36, s27, 1
    s_mul_i32 s36, s36, 64
    s_add_u32 s36, s36, s28
    v_max_f32 v48, v16, v20
    v_max3_f32 v48, v48, v24, v28
    v_mov_b32 v50, 0
    v_mov_b32 v51, 0
    v_sub_f32 v52, v16, v48
    v_exp_f32 v52, v52
    v_add_f32 v53, v32, v33
    v_fmac_f32 v50, v52, v17
    v_fmac_f32 v51, v52, v53
    v_sub_f32 v52, v20, v48
    v_exp_f32 v52, v52
    v_add_f32 v53, v34, v35
    v_fmac_f32 v50, v52, v21
    v_fmac_f32 v51, v52, v53
    v_sub_f32 v52, v24, v48
    v_exp_f32 v52, v52
    v_add_f32 v53, v36, v37
    v_fmac_f32 v50, v52, v25
    v_fmac_f32 v51, v52, v53
    v_sub_f32 v52, v28, v48
    v_exp_f32 v52, v52
    v_add_f32 v53, v38, v39
    v_fmac_f32 v50, v52, v29
    v_fmac_f32 v51, v52, v53
    s_add_u32 s37, s36, 0
    s_lshl_b32 s38, s37, 10
    s_add_u32 s38, s38, 65536
    buffer_store_dword v51, v11, s[20:23], s38 offen offset:0
    s_lshl_b32 s38, s37, 3
    s_add_u32 s38, s38, 32768
    v_mov_b32 v54, v48
    v_mov_b32 v55, v50
    v_mov_b32 v56, 0
    v_cmp_eq_u32 vcc, 0, v0
    s_and_saveexec_b64 s[30:31], vcc
    buffer_store_dwordx2 v[54:55], v56, s[20:23], s38 offen
    s_mov_b64 exec, s[30:31]
    v_max_f32 v49, v18, v22
    v_max3_f32 v49, v49, v26, v30
    v_mov_b32 v50, 0
    v_mov_b32 v51, 0
    v_sub_f32 v52, v18, v49
    v_exp_f32 v52, v52
    v_add_f32 v53, v40, v41
    v_fmac_f32 v50, v52, v19
    v_fmac_f32 v51, v52, v53
    v_sub_f32 v52, v22, v49
    v_exp_f32 v52, v52
    v_add_f32 v53, v42, v43
    v_fmac_f32 v50, v52, v23
    v_fmac_f32 v51, v52, v53
    v_sub_f32 v52, v26, v49
    v_exp_f32 v52, v52
    v_add_f32 v53, v44, v45
    v_fmac_f32 v50, v52, v27
    v_fmac_f32 v51, v52, v53
    v_sub_f32 v52, v30, v49
    v_exp_f32 v52, v52
    v_add_f32 v53, v46, v47
    v_fmac_f32 v50, v52, v31
    v_fmac_f32 v51, v52, v53
    s_add_u32 s37, s36, 64
    s_lshl_b32 s38, s37, 10
    s_add_u32 s38, s38, 65536
    buffer_store_dword v51, v11, s[20:23], s38 offen offset:0
    s_lshl_b32 s38, s37, 3
    s_add_u32 s38, s38, 32768
    v_mov_b32 v54, v49
    v_mov_b32 v55, v50
    v_mov_b32 v56, 0
    v_cmp_eq_u32 vcc, 0, v0
    s_and_saveexec_b64 s[30:31], vcc
    buffer_store_dwordx2 v[54:55], v56, s[20:23], s38 offen
    s_mov_b64 exec, s[30:31]
K2_END:
    s_endpgm
.globl proj_kernel
.p2align 8
.type proj_kernel,@function
proj_kernel:
    s_cmp_ge_u32 s2, 92
    s_cbranch_scc1 K3_END
    s_load_dwordx2 s[4:5], s[0:1], 32
    s_load_dwordx2 s[6:7], s[0:1], 64
    s_load_dwordx2 s[8:9], s[0:1], 88
    v_and_b32 v1, 63, v0
    v_lshrrev_b32 v4, 6, v0
    s_nop 0
    v_readfirstlane_b32 s24, v4
    s_waitcnt lgkmcnt(0)
    s_mov_b32 s12, s4
    s_and_b32 s13, s5, 0xffff
    s_mov_b32 s14, 0x380000
    s_mov_b32 s15, 0x00020000
    s_mov_b32 s16, s6
    s_and_b32 s17, s7, 0xffff
    s_mov_b32 s18, 0x188000
    s_mov_b32 s19, 0x00020000
    s_mov_b32 s20, s8
    s_and_b32 s21, s9, 0xffff
    s_mov_b32 s22, 0x40000000
    s_mov_b32 s23, 0x00020000
    s_cmp_ge_u32 s24, 2
    s_cbranch_scc1 K3_GEMV0
    s_cmp_ge_u32 s2, 64
    s_cbranch_scc1 K3_HLOAD
    s_lshr_b32 s25, s2, 2
    s_lshl_b32 s26, s24, 4
    s_add_u32 s25, s25, s26
    s_mul_i32 s25, s25, 64
    v_lshlrev_b32 v2, 3, v1
    s_lshl_b32 s26, s25, 3
    s_add_u32 s26, s26, 32768
    buffer_load_dwordx2 v[6:7], v2, s[20:23], s26 offen
    s_waitcnt vmcnt(0)
    s_and_b32 s27, s2, 3
    s_lshl_b32 s27, s27, 8
    s_lshl_b32 s26, s25, 10
    s_add_u32 s26, s26, s27
    s_add_u32 s26, s26, 65536
    v_lshlrev_b32 v3, 2, v1
    buffer_load_dword v32, v3, s[20:23], s26 offen offset:0
    buffer_load_dword v33, v3, s[20:23], s26 offen offset:1024
    buffer_load_dword v34, v3, s[20:23], s26 offen offset:2048
    buffer_load_dword v35, v3, s[20:23], s26 offen offset:3072
    s_add_u32 s26, s26, 4096
    buffer_load_dword v36, v3, s[20:23], s26 offen offset:0
    buffer_load_dword v37, v3, s[20:23], s26 offen offset:1024
    buffer_load_dword v38, v3, s[20:23], s26 offen offset:2048
    buffer_load_dword v39, v3, s[20:23], s26 offen offset:3072
    s_add_u32 s26, s26, 4096
    buffer_load_dword v40, v3, s[20:23], s26 offen offset:0
    buffer_load_dword v41, v3, s[20:23], s26 offen offset:1024
    buffer_load_dword v42, v3, s[20:23], s26 offen offset:2048
    buffer_load_dword v43, v3, s[20:23], s26 offen offset:3072
    s_add_u32 s26, s26, 4096
    buffer_load_dword v44, v3, s[20:23], s26 offen offset:0
    buffer_load_dword v45, v3, s[20:23], s26 offen offset:1024
    buffer_load_dword v46, v3, s[20:23], s26 offen offset:2048
    buffer_load_dword v47, v3, s[20:23], s26 offen offset:3072
    s_add_u32 s26, s26, 4096
    buffer_load_dword v48, v3, s[20:23], s26 offen offset:0
    buffer_load_dword v49, v3, s[20:23], s26 offen offset:1024
    buffer_load_dword v50, v3, s[20:23], s26 offen offset:2048
    buffer_load_dword v51, v3, s[20:23], s26 offen offset:3072
    s_add_u32 s26, s26, 4096
    buffer_load_dword v52, v3, s[20:23], s26 offen offset:0
    buffer_load_dword v53, v3, s[20:23], s26 offen offset:1024
    buffer_load_dword v54, v3, s[20:23], s26 offen offset:2048
    buffer_load_dword v55, v3, s[20:23], s26 offen offset:3072
    s_add_u32 s26, s26, 4096
    buffer_load_dword v56, v3, s[20:23], s26 offen offset:0
    buffer_load_dword v57, v3, s[20:23], s26 offen offset:1024
    buffer_load_dword v58, v3, s[20:23], s26 offen offset:2048
    buffer_load_dword v59, v3, s[20:23], s26 offen offset:3072
    s_add_u32 s26, s26, 4096
    buffer_load_dword v60, v3, s[20:23], s26 offen offset:0
    buffer_load_dword v61, v3, s[20:23], s26 offen offset:1024
    buffer_load_dword v62, v3, s[20:23], s26 offen offset:2048
    buffer_load_dword v63, v3, s[20:23], s26 offen offset:3072
    s_add_u32 s26, s26, 4096
    buffer_load_dword v64, v3, s[20:23], s26 offen offset:0
    buffer_load_dword v65, v3, s[20:23], s26 offen offset:1024
    buffer_load_dword v66, v3, s[20:23], s26 offen offset:2048
    buffer_load_dword v67, v3, s[20:23], s26 offen offset:3072
    s_add_u32 s26, s26, 4096
    buffer_load_dword v68, v3, s[20:23], s26 offen offset:0
    buffer_load_dword v69, v3, s[20:23], s26 offen offset:1024
    buffer_load_dword v70, v3, s[20:23], s26 offen offset:2048
    buffer_load_dword v71, v3, s[20:23], s26 offen offset:3072
    s_add_u32 s26, s26, 4096
    buffer_load_dword v72, v3, s[20:23], s26 offen offset:0
    buffer_load_dword v73, v3, s[20:23], s26 offen offset:1024
    buffer_load_dword v74, v3, s[20:23], s26 offen offset:2048
    buffer_load_dword v75, v3, s[20:23], s26 offen offset:3072
    s_add_u32 s26, s26, 4096
    buffer_load_dword v76, v3, s[20:23], s26 offen offset:0
    buffer_load_dword v77, v3, s[20:23], s26 offen offset:1024
    buffer_load_dword v78, v3, s[20:23], s26 offen offset:2048
    buffer_load_dword v79, v3, s[20:23], s26 offen offset:3072
    s_add_u32 s26, s26, 4096
    s_waitcnt vmcnt(32)
    buffer_load_dword v80, v3, s[20:23], s26 offen offset:0
    buffer_load_dword v81, v3, s[20:23], s26 offen offset:1024
    buffer_load_dword v82, v3, s[20:23], s26 offen offset:2048
    buffer_load_dword v83, v3, s[20:23], s26 offen offset:3072
    s_add_u32 s26, s26, 4096
    buffer_load_dword v84, v3, s[20:23], s26 offen offset:0
    buffer_load_dword v85, v3, s[20:23], s26 offen offset:1024
    buffer_load_dword v86, v3, s[20:23], s26 offen offset:2048
    buffer_load_dword v87, v3, s[20:23], s26 offen offset:3072
    s_add_u32 s26, s26, 4096
    buffer_load_dword v88, v3, s[20:23], s26 offen offset:0
    buffer_load_dword v89, v3, s[20:23], s26 offen offset:1024
    buffer_load_dword v90, v3, s[20:23], s26 offen offset:2048
    buffer_load_dword v91, v3, s[20:23], s26 offen offset:3072
    s_add_u32 s26, s26, 4096
    buffer_load_dword v92, v3, s[20:23], s26 offen offset:0
    buffer_load_dword v93, v3, s[20:23], s26 offen offset:1024
    buffer_load_dword v94, v3, s[20:23], s26 offen offset:2048
    buffer_load_dword v95, v3, s[20:23], s26 offen offset:3072
    v_mov_b32 v8, v6
    s_nop 1
    v_max_f32_dpp v8, v8, v8 row_shr:1 row_mask:0xf bank_mask:0xf
    s_nop 1
    v_max_f32_dpp v8, v8, v8 row_shr:2 row_mask:0xf bank_mask:0xf
    s_nop 1
    v_max_f32_dpp v8, v8, v8 row_shr:4 row_mask:0xf bank_mask:0xf
    s_nop 1
    v_max_f32_dpp v8, v8, v8 row_shr:8 row_mask:0xf bank_mask:0xf
    s_nop 1
    v_max_f32_dpp v8, v8, v8 row_bcast:15 row_mask:0xa bank_mask:0xf
    s_nop 1
    v_max_f32_dpp v8, v8, v8 row_bcast:31 row_mask:0xc bank_mask:0xf
    s_nop 1
    v_readlane_b32 s30, v8, 63
    s_nop 1
    v_subrev_f32 v8, s30, v6
    v_exp_f32 v8, v8
    s_nop 0
    v_mul_f32 v9, v8, v7
    s_nop 1
    v_add_f32_dpp v9, v9, v9 row_shr:1 row_mask:0xf bank_mask:0xf bound_ctrl:0
    s_nop 1
    v_add_f32_dpp v9, v9, v9 row_shr:2 row_mask:0xf bank_mask:0xf bound_ctrl:0
    s_nop 1
    v_add_f32_dpp v9, v9, v9 row_shr:4 row_mask:0xf bank_mask:0xf bound_ctrl:0
    s_nop 1
    v_add_f32_dpp v9, v9, v9 row_shr:8 row_mask:0xf bank_mask:0xf bound_ctrl:0
    s_nop 1
    v_add_f32_dpp v9, v9, v9 row_bcast:15 row_mask:0xa bank_mask:0xf
    s_nop 1
    v_add_f32_dpp v9, v9, v9 row_bcast:31 row_mask:0xc bank_mask:0xf
    s_nop 1
    v_readlane_b32 s31, v9, 63
    s_nop 1
    v_rcp_f32 v9, s31
    s_nop 0
    v_mul_f32 v8, v8, v9
    v_mov_b32 v10, 0
    s_waitcnt vmcnt(0)
    v_readlane_b32 s32, v8, 0
    s_nop 1
    v_fmac_f32 v10, s32, v32
    v_readlane_b32 s32, v8, 1
    s_nop 1
    v_fmac_f32 v10, s32, v33
    v_readlane_b32 s32, v8, 2
    s_nop 1
    v_fmac_f32 v10, s32, v34
    v_readlane_b32 s32, v8, 3
    s_nop 1
    v_fmac_f32 v10, s32, v35
    v_readlane_b32 s32, v8, 4
    s_nop 1
    v_fmac_f32 v10, s32, v36
    v_readlane_b32 s32, v8, 5
    s_nop 1
    v_fmac_f32 v10, s32, v37
    v_readlane_b32 s32, v8, 6
    s_nop 1
    v_fmac_f32 v10, s32, v38
    v_readlane_b32 s32, v8, 7
    s_nop 1
    v_fmac_f32 v10, s32, v39
    v_readlane_b32 s32, v8, 8
    s_nop 1
    v_fmac_f32 v10, s32, v40
    v_readlane_b32 s32, v8, 9
    s_nop 1
    v_fmac_f32 v10, s32, v41
    v_readlane_b32 s32, v8, 10
    s_nop 1
    v_fmac_f32 v10, s32, v42
    v_readlane_b32 s32, v8, 11
    s_nop 1
    v_fmac_f32 v10, s32, v43
    v_readlane_b32 s32, v8, 12
    s_nop 1
    v_fmac_f32 v10, s32, v44
    v_readlane_b32 s32, v8, 13
    s_nop 1
    v_fmac_f32 v10, s32, v45
    v_readlane_b32 s32, v8, 14
    s_nop 1
    v_fmac_f32 v10, s32, v46
    v_readlane_b32 s32, v8, 15
    s_nop 1
    v_fmac_f32 v10, s32, v47
    v_readlane_b32 s32, v8, 16
    s_nop 1
    v_fmac_f32 v10, s32, v48
    v_readlane_b32 s32, v8, 17
    s_nop 1
    v_fmac_f32 v10, s32, v49
    v_readlane_b32 s32, v8, 18
    s_nop 1
    v_fmac_f32 v10, s32, v50
    v_readlane_b32 s32, v8, 19
    s_nop 1
    v_fmac_f32 v10, s32, v51
    v_readlane_b32 s32, v8, 20
    s_nop 1
    v_fmac_f32 v10, s32, v52
    v_readlane_b32 s32, v8, 21
    s_nop 1
    v_fmac_f32 v10, s32, v53
    v_readlane_b32 s32, v8, 22
    s_nop 1
    v_fmac_f32 v10, s32, v54
    v_readlane_b32 s32, v8, 23
    s_nop 1
    v_fmac_f32 v10, s32, v55
    v_readlane_b32 s32, v8, 24
    s_nop 1
    v_fmac_f32 v10, s32, v56
    v_readlane_b32 s32, v8, 25
    s_nop 1
    v_fmac_f32 v10, s32, v57
    v_readlane_b32 s32, v8, 26
    s_nop 1
    v_fmac_f32 v10, s32, v58
    v_readlane_b32 s32, v8, 27
    s_nop 1
    v_fmac_f32 v10, s32, v59
    v_readlane_b32 s32, v8, 28
    s_nop 1
    v_fmac_f32 v10, s32, v60
    v_readlane_b32 s32, v8, 29
    s_nop 1
    v_fmac_f32 v10, s32, v61
    v_readlane_b32 s32, v8, 30
    s_nop 1
    v_fmac_f32 v10, s32, v62
    v_readlane_b32 s32, v8, 31
    s_nop 1
    v_fmac_f32 v10, s32, v63
    v_readlane_b32 s32, v8, 32
    s_nop 1
    v_fmac_f32 v10, s32, v64
    v_readlane_b32 s32, v8, 33
    s_nop 1
    v_fmac_f32 v10, s32, v65
    v_readlane_b32 s32, v8, 34
    s_nop 1
    v_fmac_f32 v10, s32, v66
    v_readlane_b32 s32, v8, 35
    s_nop 1
    v_fmac_f32 v10, s32, v67
    v_readlane_b32 s32, v8, 36
    s_nop 1
    v_fmac_f32 v10, s32, v68
    v_readlane_b32 s32, v8, 37
    s_nop 1
    v_fmac_f32 v10, s32, v69
    v_readlane_b32 s32, v8, 38
    s_nop 1
    v_fmac_f32 v10, s32, v70
    v_readlane_b32 s32, v8, 39
    s_nop 1
    v_fmac_f32 v10, s32, v71
    v_readlane_b32 s32, v8, 40
    s_nop 1
    v_fmac_f32 v10, s32, v72
    v_readlane_b32 s32, v8, 41
    s_nop 1
    v_fmac_f32 v10, s32, v73
    v_readlane_b32 s32, v8, 42
    s_nop 1
    v_fmac_f32 v10, s32, v74
    v_readlane_b32 s32, v8, 43
    s_nop 1
    v_fmac_f32 v10, s32, v75
    v_readlane_b32 s32, v8, 44
    s_nop 1
    v_fmac_f32 v10, s32, v76
    v_readlane_b32 s32, v8, 45
    s_nop 1
    v_fmac_f32 v10, s32, v77
    v_readlane_b32 s32, v8, 46
    s_nop 1
    v_fmac_f32 v10, s32, v78
    v_readlane_b32 s32, v8, 47
    s_nop 1
    v_fmac_f32 v10, s32, v79
    v_readlane_b32 s32, v8, 48
    s_nop 1
    v_fmac_f32 v10, s32, v80
    v_readlane_b32 s32, v8, 49
    s_nop 1
    v_fmac_f32 v10, s32, v81
    v_readlane_b32 s32, v8, 50
    s_nop 1
    v_fmac_f32 v10, s32, v82
    v_readlane_b32 s32, v8, 51
    s_nop 1
    v_fmac_f32 v10, s32, v83
    v_readlane_b32 s32, v8, 52
    s_nop 1
    v_fmac_f32 v10, s32, v84
    v_readlane_b32 s32, v8, 53
    s_nop 1
    v_fmac_f32 v10, s32, v85
    v_readlane_b32 s32, v8, 54
    s_nop 1
    v_fmac_f32 v10, s32, v86
    v_readlane_b32 s32, v8, 55
    s_nop 1
    v_fmac_f32 v10, s32, v87
    v_readlane_b32 s32, v8, 56
    s_nop 1
    v_fmac_f32 v10, s32, v88
    v_readlane_b32 s32, v8, 57
    s_nop 1
    v_fmac_f32 v10, s32, v89
    v_readlane_b32 s32, v8, 58
    s_nop 1
    v_fmac_f32 v10, s32, v90
    v_readlane_b32 s32, v8, 59
    s_nop 1
    v_fmac_f32 v10, s32, v91
    v_readlane_b32 s32, v8, 60
    s_nop 1
    v_fmac_f32 v10, s32, v92
    v_readlane_b32 s32, v8, 61
    s_nop 1
    v_fmac_f32 v10, s32, v93
    v_readlane_b32 s32, v8, 62
    s_nop 1
    v_fmac_f32 v10, s32, v94
    v_readlane_b32 s32, v8, 63
    s_nop 1
    v_fmac_f32 v10, s32, v95
    v_cvt_pk_bf16_f32 v10, v10, v10
    v_lshlrev_b32 v10, 16, v10
    s_branch K3_AWRITE
K3_HLOAD:
    s_sub_u32 s25, s2, 64
    s_lshl_b32 s25, s25, 7
    s_mul_i32 s26, s24, 3584
    s_add_u32 s25, s25, s26
    v_lshlrev_b32 v3, 1, v1
    s_add_u32 s25, s25, 16384
    buffer_load_ushort v10, v3, s[20:23], s25 offen
    s_waitcnt vmcnt(0)
    v_lshlrev_b32 v10, 16, v10
K3_AWRITE:
    v_lshlrev_b32 v3, 2, v0
    ds_write_b32 v3, v10
    s_waitcnt lgkmcnt(0)
K3_GEMV0:
    s_barrier
    s_cmp_ge_u32 s2, 64
    s_cbranch_scc1 K3_G2
    s_mul_i32 s25, s2, 57344
    s_branch K3_G3
K3_G2:
    s_sub_u32 s25, s2, 64
    s_mul_i32 s25, s25, 57344
    s_mov_b32 s12, s16
    s_mov_b32 s13, s17
    s_mov_b32 s14, s18
K3_G3:
    s_mul_i32 s26, s24, 14336
    s_add_u32 s25, s25, s26
    v_lshlrev_b32 v2, 4, v1
    v_cmp_gt_u32 vcc, 56, v1
    s_and_saveexec_b64 s[40:41], vcc
    buffer_load_dwordx4 v[32:35], v2, s[12:15], s25 offen offset:0
    buffer_load_dwordx4 v[36:39], v2, s[12:15], s25 offen offset:896
    buffer_load_dwordx4 v[40:43], v2, s[12:15], s25 offen offset:1792
    buffer_load_dwordx4 v[44:47], v2, s[12:15], s25 offen offset:2688
    s_add_u32 s25, s25, 3584
    buffer_load_dwordx4 v[48:51], v2, s[12:15], s25 offen offset:0
    buffer_load_dwordx4 v[52:55], v2, s[12:15], s25 offen offset:896
    buffer_load_dwordx4 v[56:59], v2, s[12:15], s25 offen offset:1792
    buffer_load_dwordx4 v[60:63], v2, s[12:15], s25 offen offset:2688
    s_add_u32 s25, s25, 3584
    buffer_load_dwordx4 v[64:67], v2, s[12:15], s25 offen offset:0
    buffer_load_dwordx4 v[68:71], v2, s[12:15], s25 offen offset:896
    buffer_load_dwordx4 v[72:75], v2, s[12:15], s25 offen offset:1792
    buffer_load_dwordx4 v[76:79], v2, s[12:15], s25 offen offset:2688
    s_add_u32 s25, s25, 3584
    buffer_load_dwordx4 v[80:83], v2, s[12:15], s25 offen offset:0
    buffer_load_dwordx4 v[84:87], v2, s[12:15], s25 offen offset:896
    buffer_load_dwordx4 v[88:91], v2, s[12:15], s25 offen offset:1792
    buffer_load_dwordx4 v[92:95], v2, s[12:15], s25 offen offset:2688
    s_lshl_b32 s26, s24, 6
    v_mov_b32 v3, s26
    ds_read_b128 v[96:99], v3 offset:0
    ds_read_b128 v[100:103], v3 offset:16
    ds_read_b128 v[104:107], v3 offset:32
    ds_read_b128 v[108:111], v3 offset:48
    ds_read_b128 v[112:115], v3 offset:256
    ds_read_b128 v[116:119], v3 offset:272
    ds_read_b128 v[120:123], v3 offset:288
    ds_read_b128 v[124:127], v3 offset:304
    v_mov_b32 v8, 0
    v_mov_b32 v9, 0
    v_mov_b32 v10, 0
    v_mov_b32 v11, 0
    v_mov_b32 v12, 0
    v_mov_b32 v13, 0
    v_mov_b32 v14, 0
    v_mov_b32 v15, 0
    v_mov_b32 v16, 0
    v_mov_b32 v17, 0
    v_mov_b32 v18, 0
    v_mov_b32 v19, 0
    v_mov_b32 v20, 0
    v_mov_b32 v21, 0
    v_mov_b32 v22, 0
    v_mov_b32 v23, 0
    s_waitcnt lgkmcnt(0)
    s_waitcnt vmcnt(15)
    v_lshlrev_b32 v28, 16, v32
    v_and_b32 v29, 0xffff0000, v32
    v_fmac_f32 v8, v96, v28
    v_fmac_f32 v9, v96, v29
    v_fmac_f32 v16, v112, v28
    v_fmac_f32 v17, v112, v29
    v_lshlrev_b32 v28, 16, v33
    v_and_b32 v29, 0xffff0000, v33
    v_fmac_f32 v10, v96, v28
    v_fmac_f32 v11, v96, v29
    v_fmac_f32 v18, v112, v28
    v_fmac_f32 v19, v112, v29
    v_lshlrev_b32 v28, 16, v34
    v_and_b32 v29, 0xffff0000, v34
    v_fmac_f32 v12, v96, v28
    v_fmac_f32 v13, v96, v29
    v_fmac_f32 v20, v112, v28
    v_fmac_f32 v21, v112, v29
    v_lshlrev_b32 v28, 16, v35
    v_and_b32 v29, 0xffff0000, v35
    v_fmac_f32 v14, v96, v28
    v_fmac_f32 v15, v96, v29
    v_fmac_f32 v22, v112, v28
    v_fmac_f32 v23, v112, v29
    s_waitcnt vmcnt(14)
    v_lshlrev_b32 v28, 16, v36
    v_and_b32 v29, 0xffff0000, v36
    v_fmac_f32 v8, v97, v28
    v_fmac_f32 v9, v97, v29
    v_fmac_f32 v16, v113, v28
    v_fmac_f32 v17, v113, v29
    v_lshlrev_b32 v28, 16, v37
    v_and_b32 v29, 0xffff0000, v37
    v_fmac_f32 v10, v97, v28
    v_fmac_f32 v11, v97, v29
    v_fmac_f32 v18, v113, v28
    v_fmac_f32 v19, v113, v29
    v_lshlrev_b32 v28, 16, v38
    v_and_b32 v29, 0xffff0000, v38
    v_fmac_f32 v12, v97, v28
    v_fmac_f32 v13, v97, v29
    v_fmac_f32 v20, v113, v28
    v_fmac_f32 v21, v113, v29
    v_lshlrev_b32 v28, 16, v39
    v_and_b32 v29, 0xffff0000, v39
    v_fmac_f32 v14, v97, v28
    v_fmac_f32 v15, v97, v29
    v_fmac_f32 v22, v113, v28
    v_fmac_f32 v23, v113, v29
    s_waitcnt vmcnt(13)
    v_lshlrev_b32 v28, 16, v40
    v_and_b32 v29, 0xffff0000, v40
    v_fmac_f32 v8, v98, v28
    v_fmac_f32 v9, v98, v29
    v_fmac_f32 v16, v114, v28
    v_fmac_f32 v17, v114, v29
    v_lshlrev_b32 v28, 16, v41
    v_and_b32 v29, 0xffff0000, v41
    v_fmac_f32 v10, v98, v28
    v_fmac_f32 v11, v98, v29
    v_fmac_f32 v18, v114, v28
    v_fmac_f32 v19, v114, v29
    v_lshlrev_b32 v28, 16, v42
    v_and_b32 v29, 0xffff0000, v42
    v_fmac_f32 v12, v98, v28
    v_fmac_f32 v13, v98, v29
    v_fmac_f32 v20, v114, v28
    v_fmac_f32 v21, v114, v29
    v_lshlrev_b32 v28, 16, v43
    v_and_b32 v29, 0xffff0000, v43
    v_fmac_f32 v14, v98, v28
    v_fmac_f32 v15, v98, v29
    v_fmac_f32 v22, v114, v28
    v_fmac_f32 v23, v114, v29
    s_waitcnt vmcnt(12)
    v_lshlrev_b32 v28, 16, v44
    v_and_b32 v29, 0xffff0000, v44
    v_fmac_f32 v8, v99, v28
    v_fmac_f32 v9, v99, v29
    v_fmac_f32 v16, v115, v28
    v_fmac_f32 v17, v115, v29
    v_lshlrev_b32 v28, 16, v45
    v_and_b32 v29, 0xffff0000, v45
    v_fmac_f32 v10, v99, v28
    v_fmac_f32 v11, v99, v29
    v_fmac_f32 v18, v115, v28
    v_fmac_f32 v19, v115, v29
    v_lshlrev_b32 v28, 16, v46
    v_and_b32 v29, 0xffff0000, v46
    v_fmac_f32 v12, v99, v28
    v_fmac_f32 v13, v99, v29
    v_fmac_f32 v20, v115, v28
    v_fmac_f32 v21, v115, v29
    v_lshlrev_b32 v28, 16, v47
    v_and_b32 v29, 0xffff0000, v47
    v_fmac_f32 v14, v99, v28
    v_fmac_f32 v15, v99, v29
    v_fmac_f32 v22, v115, v28
    v_fmac_f32 v23, v115, v29
    s_waitcnt vmcnt(11)
    v_lshlrev_b32 v28, 16, v48
    v_and_b32 v29, 0xffff0000, v48
    v_fmac_f32 v8, v100, v28
    v_fmac_f32 v9, v100, v29
    v_fmac_f32 v16, v116, v28
    v_fmac_f32 v17, v116, v29
    v_lshlrev_b32 v28, 16, v49
    v_and_b32 v29, 0xffff0000, v49
    v_fmac_f32 v10, v100, v28
    v_fmac_f32 v11, v100, v29
    v_fmac_f32 v18, v116, v28
    v_fmac_f32 v19, v116, v29
    v_lshlrev_b32 v28, 16, v50
    v_and_b32 v29, 0xffff0000, v50
    v_fmac_f32 v12, v100, v28
    v_fmac_f32 v13, v100, v29
    v_fmac_f32 v20, v116, v28
    v_fmac_f32 v21, v116, v29
    v_lshlrev_b32 v28, 16, v51
    v_and_b32 v29, 0xffff0000, v51
    v_fmac_f32 v14, v100, v28
    v_fmac_f32 v15, v100, v29
    v_fmac_f32 v22, v116, v28
    v_fmac_f32 v23, v116, v29
    s_waitcnt vmcnt(10)
    v_lshlrev_b32 v28, 16, v52
    v_and_b32 v29, 0xffff0000, v52
    v_fmac_f32 v8, v101, v28
    v_fmac_f32 v9, v101, v29
    v_fmac_f32 v16, v117, v28
    v_fmac_f32 v17, v117, v29
    v_lshlrev_b32 v28, 16, v53
    v_and_b32 v29, 0xffff0000, v53
    v_fmac_f32 v10, v101, v28
    v_fmac_f32 v11, v101, v29
    v_fmac_f32 v18, v117, v28
    v_fmac_f32 v19, v117, v29
    v_lshlrev_b32 v28, 16, v54
    v_and_b32 v29, 0xffff0000, v54
    v_fmac_f32 v12, v101, v28
    v_fmac_f32 v13, v101, v29
    v_fmac_f32 v20, v117, v28
    v_fmac_f32 v21, v117, v29
    v_lshlrev_b32 v28, 16, v55
    v_and_b32 v29, 0xffff0000, v55
    v_fmac_f32 v14, v101, v28
    v_fmac_f32 v15, v101, v29
    v_fmac_f32 v22, v117, v28
    v_fmac_f32 v23, v117, v29
    s_waitcnt vmcnt(9)
    v_lshlrev_b32 v28, 16, v56
    v_and_b32 v29, 0xffff0000, v56
    v_fmac_f32 v8, v102, v28
    v_fmac_f32 v9, v102, v29
    v_fmac_f32 v16, v118, v28
    v_fmac_f32 v17, v118, v29
    v_lshlrev_b32 v28, 16, v57
    v_and_b32 v29, 0xffff0000, v57
    v_fmac_f32 v10, v102, v28
    v_fmac_f32 v11, v102, v29
    v_fmac_f32 v18, v118, v28
    v_fmac_f32 v19, v118, v29
    v_lshlrev_b32 v28, 16, v58
    v_and_b32 v29, 0xffff0000, v58
    v_fmac_f32 v12, v102, v28
    v_fmac_f32 v13, v102, v29
    v_fmac_f32 v20, v118, v28
    v_fmac_f32 v21, v118, v29
    v_lshlrev_b32 v28, 16, v59
    v_and_b32 v29, 0xffff0000, v59
    v_fmac_f32 v14, v102, v28
    v_fmac_f32 v15, v102, v29
    v_fmac_f32 v22, v118, v28
    v_fmac_f32 v23, v118, v29
    s_waitcnt vmcnt(8)
    v_lshlrev_b32 v28, 16, v60
    v_and_b32 v29, 0xffff0000, v60
    v_fmac_f32 v8, v103, v28
    v_fmac_f32 v9, v103, v29
    v_fmac_f32 v16, v119, v28
    v_fmac_f32 v17, v119, v29
    v_lshlrev_b32 v28, 16, v61
    v_and_b32 v29, 0xffff0000, v61
    v_fmac_f32 v10, v103, v28
    v_fmac_f32 v11, v103, v29
    v_fmac_f32 v18, v119, v28
    v_fmac_f32 v19, v119, v29
    v_lshlrev_b32 v28, 16, v62
    v_and_b32 v29, 0xffff0000, v62
    v_fmac_f32 v12, v103, v28
    v_fmac_f32 v13, v103, v29
    v_fmac_f32 v20, v119, v28
    v_fmac_f32 v21, v119, v29
    v_lshlrev_b32 v28, 16, v63
    v_and_b32 v29, 0xffff0000, v63
    v_fmac_f32 v14, v103, v28
    v_fmac_f32 v15, v103, v29
    v_fmac_f32 v22, v119, v28
    v_fmac_f32 v23, v119, v29
    s_waitcnt vmcnt(7)
    v_lshlrev_b32 v28, 16, v64
    v_and_b32 v29, 0xffff0000, v64
    v_fmac_f32 v8, v104, v28
    v_fmac_f32 v9, v104, v29
    v_fmac_f32 v16, v120, v28
    v_fmac_f32 v17, v120, v29
    v_lshlrev_b32 v28, 16, v65
    v_and_b32 v29, 0xffff0000, v65
    v_fmac_f32 v10, v104, v28
    v_fmac_f32 v11, v104, v29
    v_fmac_f32 v18, v120, v28
    v_fmac_f32 v19, v120, v29
    v_lshlrev_b32 v28, 16, v66
    v_and_b32 v29, 0xffff0000, v66
    v_fmac_f32 v12, v104, v28
    v_fmac_f32 v13, v104, v29
    v_fmac_f32 v20, v120, v28
    v_fmac_f32 v21, v120, v29
    v_lshlrev_b32 v28, 16, v67
    v_and_b32 v29, 0xffff0000, v67
    v_fmac_f32 v14, v104, v28
    v_fmac_f32 v15, v104, v29
    v_fmac_f32 v22, v120, v28
    v_fmac_f32 v23, v120, v29
    s_waitcnt vmcnt(6)
    v_lshlrev_b32 v28, 16, v68
    v_and_b32 v29, 0xffff0000, v68
    v_fmac_f32 v8, v105, v28
    v_fmac_f32 v9, v105, v29
    v_fmac_f32 v16, v121, v28
    v_fmac_f32 v17, v121, v29
    v_lshlrev_b32 v28, 16, v69
    v_and_b32 v29, 0xffff0000, v69
    v_fmac_f32 v10, v105, v28
    v_fmac_f32 v11, v105, v29
    v_fmac_f32 v18, v121, v28
    v_fmac_f32 v19, v121, v29
    v_lshlrev_b32 v28, 16, v70
    v_and_b32 v29, 0xffff0000, v70
    v_fmac_f32 v12, v105, v28
    v_fmac_f32 v13, v105, v29
    v_fmac_f32 v20, v121, v28
    v_fmac_f32 v21, v121, v29
    v_lshlrev_b32 v28, 16, v71
    v_and_b32 v29, 0xffff0000, v71
    v_fmac_f32 v14, v105, v28
    v_fmac_f32 v15, v105, v29
    v_fmac_f32 v22, v121, v28
    v_fmac_f32 v23, v121, v29
    s_waitcnt vmcnt(5)
    v_lshlrev_b32 v28, 16, v72
    v_and_b32 v29, 0xffff0000, v72
    v_fmac_f32 v8, v106, v28
    v_fmac_f32 v9, v106, v29
    v_fmac_f32 v16, v122, v28
    v_fmac_f32 v17, v122, v29
    v_lshlrev_b32 v28, 16, v73
    v_and_b32 v29, 0xffff0000, v73
    v_fmac_f32 v10, v106, v28
    v_fmac_f32 v11, v106, v29
    v_fmac_f32 v18, v122, v28
    v_fmac_f32 v19, v122, v29
    v_lshlrev_b32 v28, 16, v74
    v_and_b32 v29, 0xffff0000, v74
    v_fmac_f32 v12, v106, v28
    v_fmac_f32 v13, v106, v29
    v_fmac_f32 v20, v122, v28
    v_fmac_f32 v21, v122, v29
    v_lshlrev_b32 v28, 16, v75
    v_and_b32 v29, 0xffff0000, v75
    v_fmac_f32 v14, v106, v28
    v_fmac_f32 v15, v106, v29
    v_fmac_f32 v22, v122, v28
    v_fmac_f32 v23, v122, v29
    s_waitcnt vmcnt(4)
    v_lshlrev_b32 v28, 16, v76
    v_and_b32 v29, 0xffff0000, v76
    v_fmac_f32 v8, v107, v28
    v_fmac_f32 v9, v107, v29
    v_fmac_f32 v16, v123, v28
    v_fmac_f32 v17, v123, v29
    v_lshlrev_b32 v28, 16, v77
    v_and_b32 v29, 0xffff0000, v77
    v_fmac_f32 v10, v107, v28
    v_fmac_f32 v11, v107, v29
    v_fmac_f32 v18, v123, v28
    v_fmac_f32 v19, v123, v29
    v_lshlrev_b32 v28, 16, v78
    v_and_b32 v29, 0xffff0000, v78
    v_fmac_f32 v12, v107, v28
    v_fmac_f32 v13, v107, v29
    v_fmac_f32 v20, v123, v28
    v_fmac_f32 v21, v123, v29
    v_lshlrev_b32 v28, 16, v79
    v_and_b32 v29, 0xffff0000, v79
    v_fmac_f32 v14, v107, v28
    v_fmac_f32 v15, v107, v29
    v_fmac_f32 v22, v123, v28
    v_fmac_f32 v23, v123, v29
    s_waitcnt vmcnt(3)
    v_lshlrev_b32 v28, 16, v80
    v_and_b32 v29, 0xffff0000, v80
    v_fmac_f32 v8, v108, v28
    v_fmac_f32 v9, v108, v29
    v_fmac_f32 v16, v124, v28
    v_fmac_f32 v17, v124, v29
    v_lshlrev_b32 v28, 16, v81
    v_and_b32 v29, 0xffff0000, v81
    v_fmac_f32 v10, v108, v28
    v_fmac_f32 v11, v108, v29
    v_fmac_f32 v18, v124, v28
    v_fmac_f32 v19, v124, v29
    v_lshlrev_b32 v28, 16, v82
    v_and_b32 v29, 0xffff0000, v82
    v_fmac_f32 v12, v108, v28
    v_fmac_f32 v13, v108, v29
    v_fmac_f32 v20, v124, v28
    v_fmac_f32 v21, v124, v29
    v_lshlrev_b32 v28, 16, v83
    v_and_b32 v29, 0xffff0000, v83
    v_fmac_f32 v14, v108, v28
    v_fmac_f32 v15, v108, v29
    v_fmac_f32 v22, v124, v28
    v_fmac_f32 v23, v124, v29
    s_waitcnt vmcnt(2)
    v_lshlrev_b32 v28, 16, v84
    v_and_b32 v29, 0xffff0000, v84
    v_fmac_f32 v8, v109, v28
    v_fmac_f32 v9, v109, v29
    v_fmac_f32 v16, v125, v28
    v_fmac_f32 v17, v125, v29
    v_lshlrev_b32 v28, 16, v85
    v_and_b32 v29, 0xffff0000, v85
    v_fmac_f32 v10, v109, v28
    v_fmac_f32 v11, v109, v29
    v_fmac_f32 v18, v125, v28
    v_fmac_f32 v19, v125, v29
    v_lshlrev_b32 v28, 16, v86
    v_and_b32 v29, 0xffff0000, v86
    v_fmac_f32 v12, v109, v28
    v_fmac_f32 v13, v109, v29
    v_fmac_f32 v20, v125, v28
    v_fmac_f32 v21, v125, v29
    v_lshlrev_b32 v28, 16, v87
    v_and_b32 v29, 0xffff0000, v87
    v_fmac_f32 v14, v109, v28
    v_fmac_f32 v15, v109, v29
    v_fmac_f32 v22, v125, v28
    v_fmac_f32 v23, v125, v29
    s_waitcnt vmcnt(1)
    v_lshlrev_b32 v28, 16, v88
    v_and_b32 v29, 0xffff0000, v88
    v_fmac_f32 v8, v110, v28
    v_fmac_f32 v9, v110, v29
    v_fmac_f32 v16, v126, v28
    v_fmac_f32 v17, v126, v29
    v_lshlrev_b32 v28, 16, v89
    v_and_b32 v29, 0xffff0000, v89
    v_fmac_f32 v10, v110, v28
    v_fmac_f32 v11, v110, v29
    v_fmac_f32 v18, v126, v28
    v_fmac_f32 v19, v126, v29
    v_lshlrev_b32 v28, 16, v90
    v_and_b32 v29, 0xffff0000, v90
    v_fmac_f32 v12, v110, v28
    v_fmac_f32 v13, v110, v29
    v_fmac_f32 v20, v126, v28
    v_fmac_f32 v21, v126, v29
    v_lshlrev_b32 v28, 16, v91
    v_and_b32 v29, 0xffff0000, v91
    v_fmac_f32 v14, v110, v28
    v_fmac_f32 v15, v110, v29
    v_fmac_f32 v22, v126, v28
    v_fmac_f32 v23, v126, v29
    s_waitcnt vmcnt(0)
    v_lshlrev_b32 v28, 16, v92
    v_and_b32 v29, 0xffff0000, v92
    v_fmac_f32 v8, v111, v28
    v_fmac_f32 v9, v111, v29
    v_fmac_f32 v16, v127, v28
    v_fmac_f32 v17, v127, v29
    v_lshlrev_b32 v28, 16, v93
    v_and_b32 v29, 0xffff0000, v93
    v_fmac_f32 v10, v111, v28
    v_fmac_f32 v11, v111, v29
    v_fmac_f32 v18, v127, v28
    v_fmac_f32 v19, v127, v29
    v_lshlrev_b32 v28, 16, v94
    v_and_b32 v29, 0xffff0000, v94
    v_fmac_f32 v12, v111, v28
    v_fmac_f32 v13, v111, v29
    v_fmac_f32 v20, v127, v28
    v_fmac_f32 v21, v127, v29
    v_lshlrev_b32 v28, 16, v95
    v_and_b32 v29, 0xffff0000, v95
    v_fmac_f32 v14, v111, v28
    v_fmac_f32 v15, v111, v29
    v_fmac_f32 v22, v127, v28
    v_fmac_f32 v23, v127, v29
    s_mul_i32 s26, s24, 3584
    v_lshlrev_b32 v3, 5, v1
    v_add_u32 v3, s26, v3
    ds_write_b128 v3, v[8:11] offset:1024
    ds_write_b128 v3, v[12:15] offset:1040
    ds_write_b128 v3, v[16:19] offset:2816
    ds_write_b128 v3, v[20:23] offset:2832
    s_mov_b64 exec, s[40:41]
    s_waitcnt lgkmcnt(0)
    s_barrier
    s_mul_i32 s26, s2, 3584
    s_add_u32 s26, s26, 2162688
    v_add_u32 v4, 0, v0
    v_cmp_gt_u32 vcc, 896, v4
    s_and_saveexec_b64 s[40:41], vcc
    v_lshlrev_b32 v3, 2, v4
    ds_read_b32 v8, v3 offset:1024
    ds_read_b32 v9, v3 offset:4608
    ds_read_b32 v10, v3 offset:8192
    ds_read_b32 v11, v3 offset:11776
    s_waitcnt lgkmcnt(0)
    v_add_f32 v8, v8, v9
    v_add_f32 v10, v10, v11
    v_add_f32 v8, v8, v10
    buffer_store_dword v8, v3, s[20:23], s26 offen
    s_mov_b64 exec, s[40:41]
    v_add_u32 v4, 256, v0
    v_cmp_gt_u32 vcc, 896, v4
    s_and_saveexec_b64 s[40:41], vcc
    v_lshlrev_b32 v3, 2, v4
    ds_read_b32 v8, v3 offset:1024
    ds_read_b32 v9, v3 offset:4608
    ds_read_b32 v10, v3 offset:8192
    ds_read_b32 v11, v3 offset:11776
    s_waitcnt lgkmcnt(0)
    v_add_f32 v8, v8, v9
    v_add_f32 v10, v10, v11
    v_add_f32 v8, v8, v10
    buffer_store_dword v8, v3, s[20:23], s26 offen
    s_mov_b64 exec, s[40:41]
    v_add_u32 v4, 512, v0
    v_cmp_gt_u32 vcc, 896, v4
    s_and_saveexec_b64 s[40:41], vcc
    v_lshlrev_b32 v3, 2, v4
    ds_read_b32 v8, v3 offset:1024
    ds_read_b32 v9, v3 offset:4608
    ds_read_b32 v10, v3 offset:8192
    ds_read_b32 v11, v3 offset:11776
    s_waitcnt lgkmcnt(0)
    v_add_f32 v8, v8, v9
    v_add_f32 v10, v10, v11
    v_add_f32 v8, v8, v10
    buffer_store_dword v8, v3, s[20:23], s26 offen
    s_mov_b64 exec, s[40:41]
    v_add_u32 v4, 768, v0
    v_cmp_gt_u32 vcc, 896, v4
    s_and_saveexec_b64 s[40:41], vcc
    v_lshlrev_b32 v3, 2, v4
    ds_read_b32 v8, v3 offset:1024
    ds_read_b32 v9, v3 offset:4608
    ds_read_b32 v10, v3 offset:8192
    ds_read_b32 v11, v3 offset:11776
    s_waitcnt lgkmcnt(0)
    v_add_f32 v8, v8, v9
    v_add_f32 v10, v10, v11
    v_add_f32 v8, v8, v10
    buffer_store_dword v8, v3, s[20:23], s26 offen
    s_mov_b64 exec, s[40:41]
K3_END:
    s_endpgm
.globl parallel_sum__gqa_block_cached__geglu_ffn__decode_kernel
.p2align 8
.type parallel_sum__gqa_block_cached__geglu_ffn__decode_kernel,@function
parallel_sum__gqa_block_cached__geglu_ffn__decode_kernel:
    s_lshl_b32 s3, s2, 8
    v_add_u32 v1, s3, v0
    v_cmp_gt_u32 vcc, 896, v1
    s_and_saveexec_b64 s[40:41], vcc
    s_cbranch_execz K4_END
    s_load_dwordx2 s[4:5], s[0:1], 0
    s_load_dwordx2 s[6:7], s[0:1], 72
    s_load_dwordx2 s[8:9], s[0:1], 88
    s_waitcnt lgkmcnt(0)
    s_mov_b32 s12, s4
    s_and_b32 s13, s5, 0xffff
    s_mov_b32 s14, 0x700
    s_mov_b32 s15, 0x00020000
    s_mov_b32 s16, s6
    s_and_b32 s17, s7, 0xffff
    s_mov_b32 s18, 0x700
    s_mov_b32 s19, 0x00020000
    s_mov_b32 s20, s8
    s_and_b32 s21, s9, 0xffff
    s_mov_b32 s22, 0x40000000
    s_mov_b32 s23, 0x00020000
    v_lshlrev_b32 v2, 2, v1
    v_lshlrev_b32 v3, 1, v1
    buffer_load_ushort v4, v3, s[12:15], 0 offen
    s_mov_b32 s24, 2162688
    buffer_load_dword v16, v2, s[20:23], s24 offen
    s_add_u32 s24, s24, 3584
    buffer_load_dword v17, v2, s[20:23], s24 offen
    s_add_u32 s24, s24, 3584
    buffer_load_dword v18, v2, s[20:23], s24 offen
    s_add_u32 s24, s24, 3584
    buffer_load_dword v19, v2, s[20:23], s24 offen
    s_add_u32 s24, s24, 3584
    buffer_load_dword v20, v2, s[20:23], s24 offen
    s_add_u32 s24, s24, 3584
    buffer_load_dword v21, v2, s[20:23], s24 offen
    s_add_u32 s24, s24, 3584
    buffer_load_dword v22, v2, s[20:23], s24 offen
    s_add_u32 s24, s24, 3584
    buffer_load_dword v23, v2, s[20:23], s24 offen
    s_add_u32 s24, s24, 3584
    buffer_load_dword v24, v2, s[20:23], s24 offen
    s_add_u32 s24, s24, 3584
    buffer_load_dword v25, v2, s[20:23], s24 offen
    s_add_u32 s24, s24, 3584
    buffer_load_dword v26, v2, s[20:23], s24 offen
    s_add_u32 s24, s24, 3584
    buffer_load_dword v27, v2, s[20:23], s24 offen
    s_add_u32 s24, s24, 3584
    buffer_load_dword v28, v2, s[20:23], s24 offen
    s_add_u32 s24, s24, 3584
    buffer_load_dword v29, v2, s[20:23], s24 offen
    s_add_u32 s24, s24, 3584
    buffer_load_dword v30, v2, s[20:23], s24 offen
    s_add_u32 s24, s24, 3584
    buffer_load_dword v31, v2, s[20:23], s24 offen
    s_add_u32 s24, s24, 3584
    buffer_load_dword v32, v2, s[20:23], s24 offen
    s_add_u32 s24, s24, 3584
    buffer_load_dword v33, v2, s[20:23], s24 offen
    s_add_u32 s24, s24, 3584
    buffer_load_dword v34, v2, s[20:23], s24 offen
    s_add_u32 s24, s24, 3584
    buffer_load_dword v35, v2, s[20:23], s24 offen
    s_add_u32 s24, s24, 3584
    buffer_load_dword v36, v2, s[20:23], s24 offen
    s_add_u32 s24, s24, 3584
    buffer_load_dword v37, v2, s[20:23], s24 offen
    s_add_u32 s24, s24, 3584
    buffer_load_dword v38, v2, s[20:23], s24 offen
    s_add_u32 s24, s24, 3584
    buffer_load_dword v39, v2, s[20:23], s24 offen
    s_add_u32 s24, s24, 3584
    buffer_load_dword v40, v2, s[20:23], s24 offen
    s_add_u32 s24, s24, 3584
    buffer_load_dword v41, v2, s[20:23], s24 offen
    s_add_u32 s24, s24, 3584
    buffer_load_dword v42, v2, s[20:23], s24 offen
    s_add_u32 s24, s24, 3584
    buffer_load_dword v43, v2, s[20:23], s24 offen
    s_add_u32 s24, s24, 3584
    buffer_load_dword v44, v2, s[20:23], s24 offen
    s_add_u32 s24, s24, 3584
    buffer_load_dword v45, v2, s[20:23], s24 offen
    s_add_u32 s24, s24, 3584
    buffer_load_dword v46, v2, s[20:23], s24 offen
    s_add_u32 s24, s24, 3584
    buffer_load_dword v47, v2, s[20:23], s24 offen
    s_add_u32 s24, s24, 3584
    buffer_load_dword v48, v2, s[20:23], s24 offen
    s_add_u32 s24, s24, 3584
    buffer_load_dword v49, v2, s[20:23], s24 offen
    s_add_u32 s24, s24, 3584
    buffer_load_dword v50, v2, s[20:23], s24 offen
    s_add_u32 s24, s24, 3584
    buffer_load_dword v51, v2, s[20:23], s24 offen
    s_add_u32 s24, s24, 3584
    buffer_load_dword v52, v2, s[20:23], s24 offen
    s_add_u32 s24, s24, 3584
    buffer_load_dword v53, v2, s[20:23], s24 offen
    s_add_u32 s24, s24, 3584
    buffer_load_dword v54, v2, s[20:23], s24 offen
    s_add_u32 s24, s24, 3584
    buffer_load_dword v55, v2, s[20:23], s24 offen
    s_add_u32 s24, s24, 3584
    buffer_load_dword v56, v2, s[20:23], s24 offen
    s_add_u32 s24, s24, 3584
    buffer_load_dword v57, v2, s[20:23], s24 offen
    s_add_u32 s24, s24, 3584
    buffer_load_dword v58, v2, s[20:23], s24 offen
    s_add_u32 s24, s24, 3584
    buffer_load_dword v59, v2, s[20:23], s24 offen
    s_add_u32 s24, s24, 3584
    buffer_load_dword v60, v2, s[20:23], s24 offen
    s_add_u32 s24, s24, 3584
    buffer_load_dword v61, v2, s[20:23], s24 offen
    s_add_u32 s24, s24, 3584
    buffer_load_dword v62, v2, s[20:23], s24 offen
    s_add_u32 s24, s24, 3584
    buffer_load_dword v63, v2, s[20:23], s24 offen
    s_add_u32 s24, s24, 3584
    buffer_load_dword v64, v2, s[20:23], s24 offen
    s_add_u32 s24, s24, 3584
    buffer_load_dword v65, v2, s[20:23], s24 offen
    s_add_u32 s24, s24, 3584
    buffer_load_dword v66, v2, s[20:23], s24 offen
    s_add_u32 s24, s24, 3584
    buffer_load_dword v67, v2, s[20:23], s24 offen
    s_add_u32 s24, s24, 3584
    buffer_load_dword v68, v2, s[20:23], s24 offen
    s_add_u32 s24, s24, 3584
    buffer_load_dword v69, v2, s[20:23], s24 offen
    s_add_u32 s24, s24, 3584
    buffer_load_dword v70, v2, s[20:23], s24 offen
    s_add_u32 s24, s24, 3584
    buffer_load_dword v71, v2, s[20:23], s24 offen
    s_add_u32 s24, s24, 3584
    buffer_load_dword v72, v2, s[20:23], s24 offen
    s_add_u32 s24, s24, 3584
    buffer_load_dword v73, v2, s[20:23], s24 offen
    s_add_u32 s24, s24, 3584
    buffer_load_dword v74, v2, s[20:23], s24 offen
    s_add_u32 s24, s24, 3584
    buffer_load_dword v75, v2, s[20:23], s24 offen
    s_add_u32 s24, s24, 3584
    s_waitcnt vmcnt(30)
    buffer_load_dword v76, v2, s[20:23], s24 offen
    s_add_u32 s24, s24, 3584
    buffer_load_dword v77, v2, s[20:23], s24 offen
    s_add_u32 s24, s24, 3584
    buffer_load_dword v78, v2, s[20:23], s24 offen
    s_add_u32 s24, s24, 3584
    buffer_load_dword v79, v2, s[20:23], s24 offen
    s_add_u32 s24, s24, 3584
    buffer_load_dword v80, v2, s[20:23], s24 offen
    s_add_u32 s24, s24, 3584
    buffer_load_dword v81, v2, s[20:23], s24 offen
    s_add_u32 s24, s24, 3584
    buffer_load_dword v82, v2, s[20:23], s24 offen
    s_add_u32 s24, s24, 3584
    buffer_load_dword v83, v2, s[20:23], s24 offen
    s_add_u32 s24, s24, 3584
    buffer_load_dword v84, v2, s[20:23], s24 offen
    s_add_u32 s24, s24, 3584
    buffer_load_dword v85, v2, s[20:23], s24 offen
    s_add_u32 s24, s24, 3584
    buffer_load_dword v86, v2, s[20:23], s24 offen
    s_add_u32 s24, s24, 3584
    buffer_load_dword v87, v2, s[20:23], s24 offen
    s_add_u32 s24, s24, 3584
    buffer_load_dword v88, v2, s[20:23], s24 offen
    s_add_u32 s24, s24, 3584
    buffer_load_dword v89, v2, s[20:23], s24 offen
    s_add_u32 s24, s24, 3584
    buffer_load_dword v90, v2, s[20:23], s24 offen
    s_add_u32 s24, s24, 3584
    buffer_load_dword v91, v2, s[20:23], s24 offen
    s_add_u32 s24, s24, 3584
    buffer_load_dword v92, v2, s[20:23], s24 offen
    s_add_u32 s24, s24, 3584
    buffer_load_dword v93, v2, s[20:23], s24 offen
    s_add_u32 s24, s24, 3584
    buffer_load_dword v94, v2, s[20:23], s24 offen
    s_add_u32 s24, s24, 3584
    buffer_load_dword v95, v2, s[20:23], s24 offen
    s_add_u32 s24, s24, 3584
    buffer_load_dword v96, v2, s[20:23], s24 offen
    s_add_u32 s24, s24, 3584
    buffer_load_dword v97, v2, s[20:23], s24 offen
    s_add_u32 s24, s24, 3584
    buffer_load_dword v98, v2, s[20:23], s24 offen
    s_add_u32 s24, s24, 3584
    buffer_load_dword v99, v2, s[20:23], s24 offen
    s_add_u32 s24, s24, 3584
    buffer_load_dword v100, v2, s[20:23], s24 offen
    s_add_u32 s24, s24, 3584
    buffer_load_dword v101, v2, s[20:23], s24 offen
    s_add_u32 s24, s24, 3584
    buffer_load_dword v102, v2, s[20:23], s24 offen
    s_add_u32 s24, s24, 3584
    buffer_load_dword v103, v2, s[20:23], s24 offen
    s_add_u32 s24, s24, 3584
    buffer_load_dword v104, v2, s[20:23], s24 offen
    s_add_u32 s24, s24, 3584
    buffer_load_dword v105, v2, s[20:23], s24 offen
    s_add_u32 s24, s24, 3584
    buffer_load_dword v106, v2, s[20:23], s24 offen
    s_add_u32 s24, s24, 3584
    buffer_load_dword v107, v2, s[20:23], s24 offen
    s_add_u32 s24, s24, 3584
    s_waitcnt vmcnt(0)
    v_mov_b32 v5, 0
    v_mov_b32 v6, 0
    v_add_f32 v5, v5, v16
    v_add_f32 v5, v5, v17
    v_add_f32 v5, v5, v18
    v_add_f32 v5, v5, v19
    v_add_f32 v5, v5, v20
    v_add_f32 v5, v5, v21
    v_add_f32 v5, v5, v22
    v_add_f32 v5, v5, v23
    v_add_f32 v5, v5, v24
    v_add_f32 v5, v5, v25
    v_add_f32 v5, v5, v26
    v_add_f32 v5, v5, v27
    v_add_f32 v5, v5, v28
    v_add_f32 v5, v5, v29
    v_add_f32 v5, v5, v30
    v_add_f32 v5, v5, v31
    v_add_f32 v5, v5, v32
    v_add_f32 v5, v5, v33
    v_add_f32 v5, v5, v34
    v_add_f32 v5, v5, v35
    v_add_f32 v5, v5, v36
    v_add_f32 v5, v5, v37
    v_add_f32 v5, v5, v38
    v_add_f32 v5, v5, v39
    v_add_f32 v5, v5, v40
    v_add_f32 v5, v5, v41
    v_add_f32 v5, v5, v42
    v_add_f32 v5, v5, v43
    v_add_f32 v5, v5, v44
    v_add_f32 v5, v5, v45
    v_add_f32 v5, v5, v46
    v_add_f32 v5, v5, v47
    v_add_f32 v5, v5, v48
    v_add_f32 v5, v5, v49
    v_add_f32 v5, v5, v50
    v_add_f32 v5, v5, v51
    v_add_f32 v5, v5, v52
    v_add_f32 v5, v5, v53
    v_add_f32 v5, v5, v54
    v_add_f32 v5, v5, v55
    v_add_f32 v5, v5, v56
    v_add_f32 v5, v5, v57
    v_add_f32 v5, v5, v58
    v_add_f32 v5, v5, v59
    v_add_f32 v5, v5, v60
    v_add_f32 v5, v5, v61
    v_add_f32 v5, v5, v62
    v_add_f32 v5, v5, v63
    v_add_f32 v5, v5, v64
    v_add_f32 v5, v5, v65
    v_add_f32 v5, v5, v66
    v_add_f32 v5, v5, v67
    v_add_f32 v5, v5, v68
    v_add_f32 v5, v5, v69
    v_add_f32 v5, v5, v70
    v_add_f32 v5, v5, v71
    v_add_f32 v5, v5, v72
    v_add_f32 v5, v5, v73
    v_add_f32 v5, v5, v74
    v_add_f32 v5, v5, v75
    v_add_f32 v5, v5, v76
    v_add_f32 v5, v5, v77
    v_add_f32 v5, v5, v78
    v_add_f32 v5, v5, v79
    v_add_f32 v6, v6, v80
    v_add_f32 v6, v6, v81
    v_add_f32 v6, v6, v82
    v_add_f32 v6, v6, v83
    v_add_f32 v6, v6, v84
    v_add_f32 v6, v6, v85
    v_add_f32 v6, v6, v86
    v_add_f32 v6, v6, v87
    v_add_f32 v6, v6, v88
    v_add_f32 v6, v6, v89
    v_add_f32 v6, v6, v90
    v_add_f32 v6, v6, v91
    v_add_f32 v6, v6, v92
    v_add_f32 v6, v6, v93
    v_add_f32 v6, v6, v94
    v_add_f32 v6, v6, v95
    v_add_f32 v6, v6, v96
    v_add_f32 v6, v6, v97
    v_add_f32 v6, v6, v98
    v_add_f32 v6, v6, v99
    v_add_f32 v6, v6, v100
    v_add_f32 v6, v6, v101
    v_add_f32 v6, v6, v102
    v_add_f32 v6, v6, v103
    v_add_f32 v6, v6, v104
    v_add_f32 v6, v6, v105
    v_add_f32 v6, v6, v106
    v_add_f32 v6, v6, v107
    v_cvt_pk_bf16_f32 v5, v5, v5
    v_lshlrev_b32 v5, 16, v5
    v_cvt_pk_bf16_f32 v6, v6, v6
    v_lshlrev_b32 v6, 16, v6
    v_lshlrev_b32 v4, 16, v4
    v_add_f32 v4, v4, v5
    v_cvt_pk_bf16_f32 v4, v4, v4
    v_lshlrev_b32 v4, 16, v4
    v_add_f32 v4, v4, v6
    v_cvt_pk_bf16_f32 v4, v4, v4
    buffer_store_short v4, v3, s[16:19], 0 offen
K4_END:
    s_endpgm
.section .rodata,"a"
.p2align 6
.amdhsa_kernel prep_kernel
  .amdhsa_next_free_vgpr 184
  .amdhsa_next_free_sgpr 64
  .amdhsa_accum_offset 184
  .amdhsa_group_segment_fixed_size 0
  .amdhsa_kernarg_size 96
  .amdhsa_user_sgpr_count 2
  .amdhsa_user_sgpr_kernarg_segment_ptr 1
  .amdhsa_system_sgpr_workgroup_id_x 1
.end_amdhsa_kernel
.p2align 6
.amdhsa_kernel attn_kernel
  .amdhsa_next_free_vgpr 176
  .amdhsa_next_free_sgpr 64
  .amdhsa_accum_offset 176
  .amdhsa_group_segment_fixed_size 0
  .amdhsa_kernarg_size 96
  .amdhsa_user_sgpr_count 2
  .amdhsa_user_sgpr_kernarg_segment_ptr 1
  .amdhsa_system_sgpr_workgroup_id_x 1
.end_amdhsa_kernel
.p2align 6
.amdhsa_kernel proj_kernel
  .amdhsa_next_free_vgpr 128
  .amdhsa_next_free_sgpr 64
  .amdhsa_accum_offset 128
  .amdhsa_group_segment_fixed_size 0
  .amdhsa_kernarg_size 96
  .amdhsa_user_sgpr_count 2
  .amdhsa_user_sgpr_kernarg_segment_ptr 1
  .amdhsa_system_sgpr_workgroup_id_x 1
.end_amdhsa_kernel
.p2align 6
.amdhsa_kernel parallel_sum__gqa_block_cached__geglu_ffn__decode_kernel
  .amdhsa_next_free_vgpr 112
  .amdhsa_next_free_sgpr 64
  .amdhsa_accum_offset 112
  .amdhsa_group_segment_fixed_size 0
  .amdhsa_kernarg_size 96
  .amdhsa_user_sgpr_count 2
  .amdhsa_user_sgpr_kernarg_segment_ptr 1
  .amdhsa_system_sgpr_workgroup_id_x 1
.end_amdhsa_kernel
```
